```python
import torch

def _softmax(x, axis=-1):
    return torch.softmax(x, dim=axis)
def _gelu(x):
    return torch.nn.functional.gelu(x, approximate="tanh")
def _silu(x):
    return torch.nn.functional.silu(x)
def _sigmoid(x):
    return torch.sigmoid(x)
def _layernorm(x, axis=-1, eps=1e-5):
    m = x.mean(dim=axis, keepdim=True)
    v = x.var(dim=axis, keepdim=True, unbiased=False)
    return (x - m) / torch.sqrt(v + eps)
def _scatter_add(tgt, idx, src, axis=0):
    return tgt.clone().index_add_(axis, idx, src)
def _segment_sum(src, seg, n):
    out = torch.zeros((n,) + src.shape[1:], dtype=src.dtype)
    return out.index_add_(0, seg, src)
def _pad(x, pw):
    flat = tuple(v for pair in reversed(pw) for v in pair)
    return torch.nn.functional.pad(x, flat)

kernel_name = 'parallel_sum__mha_block_cached__dense_activation_silu__decode'

def setup_inputs():

    _w = (lambda a: (lambda t: t.to(torch.bfloat16) if t.is_floating_point() else t)(torch.as_tensor(a)))
    def _A_setup():
        B, Sq, D = 4, 1, 640
        H, Sk, Dh = 32, 8192, 192
        return {
            "x": _w((lambda *s: torch.randn(*s, dtype=torch.bfloat16) * 0.05)(B, Sq, D)),
            "k_cache": _w((lambda *s: torch.randn(*s, dtype=torch.bfloat16) * 3.2)(B, H, Sk, Dh)),
            "v_cache": _w((lambda *s: torch.randn(*s, dtype=torch.bfloat16) * 0.8)(B, H, Sk, Dh)),
            "wq": _w((lambda *s: torch.randn(*s, dtype=torch.bfloat16) * 3.2)(D, H * Dh) * (D ** -0.5)),
            "wo": _w((lambda *s: torch.randn(*s, dtype=torch.bfloat16) * 0.8)(H * Dh, D) * ((H * Dh) ** -0.5)),
        }
    _A_in = _A_setup()

    def _B_setup():
        B, S, D, F = 4, 1, 640, 1536
        return {
            "x": _w((lambda *s: torch.randn(*s, dtype=torch.bfloat16) * 0.05)(B, S, D)),
            "w1": _w((lambda *s: torch.randn(*s, dtype=torch.bfloat16) * 3.2)(D, F) * (D ** -0.5)),
            "w2": _w((lambda *s: torch.randn(*s, dtype=torch.bfloat16) * 0.4)(F, D) * (F ** -0.5)),
        }
    _B_in = _B_setup()

    return {
        "A_x": _A_in["x"],
        "A_k_cache": _A_in["k_cache"],
        "A_v_cache": _A_in["v_cache"],
        "A_wq": _A_in["wq"],
        "A_wo": _A_in["wo"],
        "B_x": _B_in["x"],
        "B_w1": _B_in["w1"],
        "B_w2": _B_in["w2"],
    }

def reference(A_x, A_k_cache, A_v_cache, A_wq, A_wo, B_x, B_w1, B_w2):
    def _A_ref(x, k_cache, v_cache, wq, wo):
        B, Sq, D = x.shape
        H, Dh = 32, 192
        q = (lambda x, *d: x.permute(*d))((x @ wq).reshape(B, Sq, H, Dh), 0, 2, 1, 3)
        scores = torch.einsum("bhqd,bhkd->bhqk", q, k_cache) * (Dh ** -0.5)
        p = _softmax(scores, axis=-1)
        o = torch.einsum("bhqk,bhkd->bhqd", p, v_cache)
        return (lambda x, *d: x.permute(*d))(o, 0, 2, 1, 3).reshape(B, Sq, H * Dh) @ wo

    def _B_ref(x, w1, w2):
        h = torch.einsum("bsd,df->bsf", x, w1)
        h = _silu(h)
        out = torch.einsum("bsf,fd->bsd", h, w2)
        return out

    x = A_x
    xn = _layernorm(x, axis=-1)
    return x + _A_ref(xn, A_k_cache, A_v_cache, A_wq, A_wo) + _B_ref(xn, B_w1, B_w2)
```

```asm
; @launch grid=(256,1,1) block=(512,1,1) lds=97280
.amdgcn_target "amdgcn-amd-amdhsa--gfx950"
.text
.globl parallel_sum__mha_block_cached__dense_activation_silu__decode_kernel
.p2align 8
.type parallel_sum__mha_block_cached__dense_activation_silu__decode_kernel,@function
parallel_sum__mha_block_cached__dense_activation_silu__decode_kernel:
  s_cmp_ge_u32 s2, 256
  s_cbranch_scc1 L_exit
  s_load_dwordx16 s[16:31], s[0:1], 0
  s_cmp_ge_u32 s2, 16
  s_cbranch_scc1 L_nopf
  s_getpc_b64 s[14:15]
L_pfpc:
  v_lshlrev_b32 v3, 6, v0
  v_min_u32 v3, L_table+2044-L_pfpc, v3
  global_load_dword v254, v3, s[14:15]
L_nopf:
  s_load_dwordx4 s[32:35], s[0:1], 64
  s_load_dwordx2 s[36:37], s[0:1], 80
  s_memrealtime s[94:95]
  v_lshrrev_b32 v2, 6, v0
  v_mov_b32 v1, 0
  v_readfirstlane_b32 s3, v2
  v_and_b32 v2, 63, v0
  v_and_b32 v5, 0x7f, v0
  v_lshlrev_b32 v5, 2, v5
  ds_write_b32 v5, v1 offset:44032
  s_getreg_b32 s7, hwreg(HW_REG_XCC_ID, 0, 4)
  s_bfe_u32 s9, s7, 0x10002
  s_bfe_u32 s4, s2, 0x10002
  s_bfe_u32 s5, s2, 0x20003
  s_and_b32 s11, s2, 3
  s_lshr_b32 s10, s2, 5
  s_lshl_b32 s6, s11, 3
  s_add_u32 s6, s6, s10
  s_lshl_b32 s8, s5, 1
  s_add_u32 s8, s8, s4
  s_lshl_b32 s38, s10, 2
  s_add_u32 s38, s38, s11
  s_sub_u32 s11, s8, 5
  s_lshl_b32 s11, s11, 5
  s_add_u32 s38, s38, s11
  s_cmp_ge_u32 s3, 4
  s_cbranch_scc1 L_helper
  s_getpc_b64 s[14:15]
L_pc:
  s_add_u32 s14, s14, L_table-L_pc
  s_addc_u32 s15, s15, 0
  v_lshrrev_b32 v8, 3, v0
  v_lshlrev_b32 v8, 5, v8
  s_max_u32 s12, s2, 16
  s_sub_u32 s12, s12, 16
  s_mul_i32 s12, s12, 205
  s_lshr_b32 s12, s12, 11
  s_cmp_ge_u32 s12, 12
  s_cselect_b32 s13, 12, 0
  s_sub_u32 s10, s12, s13
  s_lshl_b32 s10, s10, 3
  s_and_b32 s11, s2, 7
  s_add_u32 s10, s10, s11
  s_lshl_b32 s10, s10, 22
  s_and_b32 s11, s2, 63
  s_lshl_b32 s11, s11, 7
  s_add_u32 s10, s10, s11
  s_add_u32 s10, s10, 0x80000
  s_add_u32 s11, s10, 0x2000
  s_mov_b32 s54, 402653184
  s_mov_b32 s55, 0x20000
  s_setprio 3
  global_load_dwordx4 v[48:51], v8, s[14:15] offset:0
  global_load_dwordx4 v[52:55], v8, s[14:15] offset:16
  global_load_dwordx4 v[56:59], v8, s[14:15] offset:1024
  global_load_dwordx4 v[60:63], v8, s[14:15] offset:1040
  s_waitcnt lgkmcnt(0)
  s_cmp_eq_u32 s13, 0
  s_cselect_b32 s52, s18, s20
  s_cselect_b32 s53, s19, s21
  s_and_b32 s53, s53, 0xffff
  s_lshr_b32 s27, s2, 3
  s_add_u32 s0, s2, s27
  s_and_b32 s0, s0, 3
  s_lshl_b32 s27, s27, 2
  s_add_u32 s27, s27, s0
  s_mul_i32 s1, s27, 171
  s_lshr_b32 s1, s1, 9
  s_mul_i32 s94, s1, 3
  s_sub_u32 s94, s27, s94
  s_lshl_b32 s95, s94, 3
  s_or_b32 s95, s95, 0x80000
  s_bfe_u32 s0, 0x150b00, s95
  s_lshl_b32 s26, s1, 5
  s_add_u32 s0, s0, s26
  s_bfe_u32 s95, 0x0b0600, s95
  s_lshl_b32 s1, s1, 4
  s_add_u32 s1, s1, s95
  s_add_u32 s1, s1, 1365
  s_movk_i32 s95, 0x400
  s_cmp_eq_u32 s94, 1
  s_cselect_b32 s26, 10, 11
  s_cselect_b32 s95, 0x210, s95
  s_cmp_eq_u32 s27, 126
  s_cselect_b32 s1, 1360, s1
  s_cmp_eq_u32 s27, 127
  s_cselect_b32 s1, s0, s1
  s_cselect_b32 s26, 5, s26
  s_cselect_b32 s95, 16, s95
  s_bitset1_b32 s95, 15
  s_waitcnt vmcnt(0)
  s_barrier
  s_cmp_lg_u32 s3, 0
  s_cbranch_scc1 L_noprobe
  s_mov_b64 exec, 1
  buffer_load_dword v6, v1, s[52:55], s10 offen nt
  buffer_load_dword v7, v1, s[52:55], s11 offen nt
  s_mov_b64 exec, -1
L_noprobe:
  s_barrier
  s_mov_b32 s44, s36
  s_and_b32 s45, s37, 0xffff
  s_mov_b32 s46, 5242880
  s_mov_b32 s47, 0x20000
  s_cmp_lg_u32 s3, 0
  s_cbranch_scc1 L_pre
  s_waitcnt vmcnt(1)
  s_memtime s[10:11]
  s_waitcnt vmcnt(0)
  s_memtime s[12:13]
  s_waitcnt lgkmcnt(0)
  s_sub_u32 s10, s12, s10
  s_cmp_le_u32 s10, 40
  s_cselect_b32 s62, 1, 0
  s_xor_b32 s62, s62, s9
  s_load_dword s92, s[34:35], 0
  s_waitcnt lgkmcnt(0)
  s_cmp_lg_u32 s92, 0
  s_cbranch_scc1 L_ndone
  s_sleep 2
  s_load_dword s92, s[34:35], 64
  s_waitcnt lgkmcnt(0)
  s_cmp_lg_u32 s92, 0
  s_cbranch_scc1 L_ndone
  s_sleep 2
  s_load_dword s92, s[34:35], 128
  s_waitcnt lgkmcnt(0)
  s_cmp_lg_u32 s92, 0
  s_cbranch_scc1 L_ndone
  s_sleep 2
  s_load_dword s92, s[34:35], 192
  s_waitcnt lgkmcnt(0)
  s_cmp_lg_u32 s92, 0
  s_cbranch_scc1 L_ndone
  s_sleep 2
  s_mov_b32 s12, 0x40000
L_npoll:
  global_load_dword v6, v1, s[34:35] sc1
  s_waitcnt vmcnt(0)
  v_readfirstlane_b32 s92, v6
  s_cmp_lg_u32 s92, 0
  s_cbranch_scc1 L_ndone
  s_sleep 4
  s_sub_u32 s12, s12, 1
  s_cbranch_scc0 L_npoll
  s_branch L_end
L_ndone:
  s_lshl_b32 s11, s7, 1
  s_or_b32 s10, s62, s11
  s_lshl_b32 s11, s2, 3
  s_add_u32 s11, s11, 1802240
  v_mov_b32 v6, s92
  v_mov_b32 v7, s10
  v_lshlrev_b32 v5, 3, v2
  s_mov_b64 exec, 1
  buffer_store_dwordx2 v[6:7], v5, s[44:47], s11 offen sc1
  s_mov_b64 exec, 0xff
  v_mov_b32 v8, 0xff7f0000
  v_mov_b32 v9, s92
  v_mov_b32 v10, 0
  v_mov_b32 v11, s92
  v_lshlrev_b32 v12, 4, v2
  ds_write_b128 v12, v[8:11] offset:44416
  ds_write_b32 v1, v6 offset:44032
  s_mov_b64 exec, -1
  s_branch L_tabok
L_pre:
  s_waitcnt vmcnt(0)
L_tabok:
  s_setprio 1
  v_mov_b32 v9, 0
  v_and_b32 v40, 7, v0
  v_lshlrev_b32 v40, 4, v40
  v_add_u32 v48, v48, v40
  v_add_u32 v49, v49, v40
  v_add_u32 v50, v50, v40
  v_add_u32 v51, v51, v40
  v_add_u32 v52, v52, v40
  v_add_u32 v53, v53, v40
  v_add_u32 v54, v54, v40
  v_add_u32 v55, v55, v40
  v_add_u32 v56, v56, v40
  v_add_u32 v57, v57, v40
  v_add_u32 v58, v58, v40
  v_add_u32 v59, v59, v40
  v_add_u32 v60, v60, v40
  v_add_u32 v61, v61, v40
  v_add_u32 v62, v62, v40
  v_add_u32 v63, v63, v40
  s_mov_b32 s40, s18
  s_and_b32 s41, s19, 0xffff
  s_mov_b32 s42, 402653184
  s_mov_b32 s43, 0x20000
  s_and_b32 s63, s21, 0xffff
  v_lshlrev_b32 v4, 1, v0
  s_mul_i32 s57, s0, 196608
  s_mov_b32 s58, 0
  s_mov_b32 s68, 0
  s_mov_b32 s69, 0
  s_lshl_b32 s70, s3, 30
  s_lshl_b32 s71, s3, 30
  s_mov_b32 s72, -4
  s_mov_b32 s93, 1
  s_lshr_b32 s10, s3, 1
  s_cmp_lg_u32 s10, s4
  s_cselect_b64 s[60:61], -1, 0
  v_cndmask_b32 v2, v48, v56, s[60:61]
  buffer_load_dwordx4 v[64:67], v2, s[40:43], s57 offen offset:0 nt
  buffer_load_dwordx4 v[68:71], v2, s[40:43], s57 offen offset:128 nt
  buffer_load_dwordx4 v[72:75], v2, s[40:43], s57 offen offset:256 nt
  v_cndmask_b32 v3, v49, v57, s[60:61]
  buffer_load_dwordx4 v[76:79], v3, s[40:43], s57 offen offset:0 nt
  buffer_load_dwordx4 v[80:83], v3, s[40:43], s57 offen offset:128 nt
  buffer_load_dwordx4 v[84:87], v3, s[40:43], s57 offen offset:256 nt
  v_cndmask_b32 v2, v50, v58, s[60:61]
  s_waitcnt vmcnt(3)
  buffer_load_dwordx4 v[88:91], v2, s[40:43], s57 offen offset:0 nt
  buffer_load_dwordx4 v[92:95], v2, s[40:43], s57 offen offset:128 nt
  buffer_load_dwordx4 v[96:99], v2, s[40:43], s57 offen offset:256 nt
  v_cndmask_b32 v3, v51, v59, s[60:61]
  s_waitcnt vmcnt(3)
  buffer_load_dwordx4 v[100:103], v3, s[40:43], s57 offen offset:0 nt
  buffer_load_dwordx4 v[104:107], v3, s[40:43], s57 offen offset:128 nt
  buffer_load_dwordx4 v[108:111], v3, s[40:43], s57 offen offset:256 nt
  v_cndmask_b32 v2, v52, v60, s[60:61]
  s_waitcnt vmcnt(3)
  buffer_load_dwordx4 v[112:115], v2, s[40:43], s57 offen offset:0 nt
  buffer_load_dwordx4 v[116:119], v2, s[40:43], s57 offen offset:128 nt
  buffer_load_dwordx4 v[120:123], v2, s[40:43], s57 offen offset:256 nt
  v_cndmask_b32 v3, v53, v61, s[60:61]
  s_waitcnt vmcnt(3)
  buffer_load_dwordx4 v[124:127], v3, s[40:43], s57 offen offset:0 nt
  buffer_load_dwordx4 v[128:131], v3, s[40:43], s57 offen offset:128 nt
  buffer_load_dwordx4 v[132:135], v3, s[40:43], s57 offen offset:256 nt
  s_cmp_lg_u32 s3, 1
  s_cbranch_scc1 L_on1
  s_mul_i32 s10, s0, 6
  s_add_u32 s10, s10, 33
  s_lshr_b32 s10, s10, 10
  s_mul_i32 s11, s1, 6
  s_add_u32 s11, s11, 81
  s_lshr_b32 s11, s11, 10
  s_sub_u32 s11, s11, s10
  v_bfe_u32 v9, v0, 4, 1
  v_mul_u32_u24 v9, s11, v9
  v_bfe_u32 v10, v0, 5, 1
  v_mad_u32_u24 v9, v10, 12, v9
  v_add_u32 v9, s10, v9
  v_and_b32 v10, 15, v0
  v_mad_u32_u24 v9, v9, 10, v10
  v_cmp_lt_u32 vcc, 8, v10
  s_andn2_b32 s11, s2, 4
  v_add_u32 v9, 16, v9
  v_mov_b32 v10, s11
  v_cndmask_b32 v9, v9, v10, vcc
  v_lshlrev_b32 v9, 3, v9
  s_mov_b32 s15, 1802240
  buffer_load_dwordx2 v[12:13], v9, s[44:47], s15 offen sc1
L_on1:
  v_cndmask_b32 v2, v54, v62, s[60:61]
  s_waitcnt vmcnt(3)
  buffer_load_dwordx4 v[136:139], v2, s[40:43], s57 offen offset:0 nt
  buffer_load_dwordx4 v[140:143], v2, s[40:43], s57 offen offset:128 nt
  buffer_load_dwordx4 v[144:147], v2, s[40:43], s57 offen offset:256 nt
  v_cndmask_b32 v3, v55, v63, s[60:61]
  s_waitcnt vmcnt(3)
  buffer_load_dwordx4 v[148:151], v3, s[40:43], s57 offen offset:0 nt
  buffer_load_dwordx4 v[152:155], v3, s[40:43], s57 offen offset:128 nt
  buffer_load_dwordx4 v[156:159], v3, s[40:43], s57 offen offset:256 nt
  s_cmp_lg_u32 s3, 1
  s_cbranch_scc1 L_on2
  s_waitcnt vmcnt(6)
  s_mov_b32 s12, 0x100000
L_sp3:
  ds_read_b32 v6, v1 offset:44032
  s_waitcnt lgkmcnt(0)
  v_readfirstlane_b32 s10, v6
  s_cmp_ge_u32 s10, 1
  s_cbranch_scc1 L_sd4
  s_sleep 0
  s_sub_u32 s12, s12, 1
  s_cbranch_scc0 L_sp3
  s_branch L_end
L_sd4:
  s_mov_b32 s92, s10
  s_mov_b32 s12, 0x40000
L_vchk:
  v_cmp_ne_u32 vcc, s92, v12
  s_cmp_eq_u64 vcc, 0
  s_cbranch_scc1 L_vok
  s_sleep 8
  buffer_load_dwordx2 v[12:13], v9, s[44:47], s15 offen sc1
  s_waitcnt vmcnt(0)
  s_sub_u32 s12, s12, 1
  s_cbranch_scc0 L_vchk
  s_branch L_end
L_vok:
  v_readlane_b32 s11, v13, 15
  v_and_b32 v9, 15, v0
  v_cmp_gt_u32 vcc, s26, v9
  v_add_u32 v10, s1, v9
  v_add_u32 v7, s0, v9
  v_cndmask_b32 v10, v10, v7, vcc
  v_cndmask_b32 v11, 16, 0, vcc
  v_and_b32 v8, 1, v13
  v_cmp_eq_u32 vcc, 1, v8
  v_and_b32 v9, 16, v0
  v_lshl_add_u32 v11, v9, 1, v11
  v_mad_u32_u24 v10, v10, 6, 3
  v_lshrrev_b32 v10, 6, v10
  s_lshr_b32 s11, s11, 3
  s_xor_b32 s11, s11, s4
  v_lshrrev_b64 v[8:9], v11, vcc
  v_and_b32 v8, 0x1ff, v8
  v_bcnt_u32_b32 v8, v8, 3
  v_lshrrev_b32 v8, 3, v8
  v_xor_b32 v8, v8, v10
  v_xor_b32 v8, s11, v8
  v_and_b32 v8, 1, v8
  v_cmp_eq_u32 vcc, 1, v8
  s_mov_b32 s59, vcc_lo
  v_mov_b32 v6, 1
  v_mov_b32 v7, s59
  ds_write_b64 v1, v[6:7] offset:44040
L_on2:
  s_mov_b32 s12, 0x100000
L_sp5:
  ds_read_b64 v[6:7], v1 offset:44040
  s_waitcnt lgkmcnt(0)
  v_readfirstlane_b32 s10, v6
  v_readfirstlane_b32 s11, v7
  s_cmp_ge_u32 s10, 1
  s_cbranch_scc1 L_sd6
  s_sleep 0
  s_sub_u32 s12, s12, 1
  s_cbranch_scc0 L_sp5
  s_branch L_end
L_sd6:
  s_mov_b32 s59, s11
  s_bitcmp1_b32 s59, 0
  s_cselect_b64 s[60:61], -1, 0
  s_add_u32 s58, s58, 1
  s_and_b32 s10, s58, 15
  s_cmp_lt_u32 s10, s26
  s_cselect_b32 s57, s0, s1
  s_add_u32 s57, s57, s10
  s_mul_i32 s57, s57, 196608
  s_bitcmp1_b32 s59, s58
  s_cselect_b64 s[60:61], -1, 0
  v_cndmask_b32 v2, v48, v56, s[60:61]
  s_waitcnt vmcnt(3)
  buffer_load_dwordx4 v[160:163], v2, s[40:43], s57 offen offset:0 nt
  buffer_load_dwordx4 v[164:167], v2, s[40:43], s57 offen offset:128 nt
  buffer_load_dwordx4 v[168:171], v2, s[40:43], s57 offen offset:256 nt
  s_mov_b32 s64, 0xcccccccc
  s_mov_b32 s65, 0xcccccccc
  s_mov_b32 s66, 0xaaaaaaaa
  s_mov_b32 s67, 0xaaaaaaaa
  v_cndmask_b32 v3, v49, v57, s[60:61]
  s_waitcnt vmcnt(3)
  buffer_load_dwordx4 v[172:175], v3, s[40:43], s57 offen offset:0 nt
  buffer_load_dwordx4 v[176:179], v3, s[40:43], s57 offen offset:128 nt
  buffer_load_dwordx4 v[180:183], v3, s[40:43], s57 offen offset:256 nt
  v_and_b32 v5, 7, v0
  v_mov_b32 v28, 0x0c0c0c0c
  v_mov_b32 v29, 0x0c0c0100
  v_mov_b32 v30, 0x01000c0c
  v_cmp_eq_u32 vcc, 0, v5
  v_cmp_eq_u32 s[10:11], 1, v5
  s_nop 0
  v_cndmask_b32 v32, v28, v29, vcc
  v_cndmask_b32 v32, v32, v30, s[10:11]
  v_cmp_eq_u32 vcc, 2, v5
  v_cmp_eq_u32 s[10:11], 3, v5
  s_nop 0
  v_cndmask_b32 v33, v28, v29, vcc
  v_cndmask_b32 v33, v33, v30, s[10:11]
  v_cmp_eq_u32 vcc, 4, v5
  v_cmp_eq_u32 s[10:11], 5, v5
  s_nop 0
  v_cndmask_b32 v34, v28, v29, vcc
  v_cndmask_b32 v34, v34, v30, s[10:11]
  v_cmp_eq_u32 vcc, 6, v5
  v_cmp_eq_u32 s[10:11], 7, v5
  s_nop 0
  v_cndmask_b32 v35, v28, v29, vcc
  v_cndmask_b32 v35, v35, v30, s[10:11]
  v_cndmask_b32 v2, v50, v58, s[60:61]
  s_waitcnt vmcnt(3)
  buffer_load_dwordx4 v[184:187], v2, s[40:43], s57 offen offset:0 nt
  buffer_load_dwordx4 v[188:191], v2, s[40:43], s57 offen offset:128 nt
  buffer_load_dwordx4 v[192:195], v2, s[40:43], s57 offen offset:256 nt
  v_and_b32 v5, 7, v0
  v_mov_b32 v28, 0x0c0c0c0c
  v_mov_b32 v29, 0x0c0c0302
  v_mov_b32 v30, 0x03020c0c
  v_cmp_eq_u32 vcc, 0, v5
  v_cmp_eq_u32 s[10:11], 1, v5
  s_nop 0
  v_cndmask_b32 v36, v28, v29, vcc
  v_cndmask_b32 v36, v36, v30, s[10:11]
  v_cmp_eq_u32 vcc, 2, v5
  v_cmp_eq_u32 s[10:11], 3, v5
  s_nop 0
  v_cndmask_b32 v37, v28, v29, vcc
  v_cndmask_b32 v37, v37, v30, s[10:11]
  v_cmp_eq_u32 vcc, 4, v5
  v_cmp_eq_u32 s[10:11], 5, v5
  s_nop 0
  v_cndmask_b32 v38, v28, v29, vcc
  v_cndmask_b32 v38, v38, v30, s[10:11]
  v_cmp_eq_u32 vcc, 6, v5
  v_cmp_eq_u32 s[10:11], 7, v5
  s_nop 0
  v_cndmask_b32 v39, v28, v29, vcc
  v_cndmask_b32 v39, v39, v30, s[10:11]
  v_cndmask_b32 v3, v51, v59, s[60:61]
  s_waitcnt vmcnt(3)
  buffer_load_dwordx4 v[196:199], v3, s[40:43], s57 offen offset:0 nt
  buffer_load_dwordx4 v[200:203], v3, s[40:43], s57 offen offset:128 nt
  buffer_load_dwordx4 v[204:207], v3, s[40:43], s57 offen offset:256 nt
  s_cmp_lg_u32 s3, 2
  s_cbranch_scc1 L_on7
  s_mov_b64 exec, 1
  v_mov_b32 v5, 1
  ds_add_u32 v1, v5 offset:44144
  s_mov_b64 exec, -1
L_on7:
  v_lshlrev_b32 v41, 1, v40
  v_bfe_u32 v6, v0, 4, 1
  v_lshl_add_u32 v41, v6, 4, v41
  v_lshrrev_b32 v6, 5, v0
  v_mul_u32_u24 v6, 768, v6
  v_add_u32 v41, v41, v6
  v_and_b32 v42, 63, v0
  v_lshlrev_b32 v42, 4, v42
  s_bcnt1_i32_b32 s10, s95
  s_sub_u32 s10, 3, s10
  s_mul_i32 s11, s10, 6144
  v_add_u32 v41, s11, v41
  s_mul_i32 s11, s10, 384
  v_add_u32 v40, s11, v40
  s_lshl_b32 s11, s10, 2
  v_mov_b32 v43, s11
  v_cndmask_b32 v2, v52, v60, s[60:61]
  s_waitcnt vmcnt(3)
  buffer_load_dwordx4 v[208:211], v2, s[40:43], s57 offen offset:0 nt
  buffer_load_dwordx4 v[212:215], v2, s[40:43], s57 offen offset:128 nt
  buffer_load_dwordx4 v[216:219], v2, s[40:43], s57 offen offset:256 nt
  s_cmp_lt_u32 15, s26
  s_cselect_b32 s11, s0, s1
  s_add_u32 s11, s11, 15
  s_lshr_b32 s11, s11, 4
  s_and_b32 s50, s11, 1
  s_cmp_ge_u32 s11, 86
  s_cselect_b32 s50, 2, s50
  s_cmp_lg_u32 s94, 1
  s_cselect_b32 s10, 1, 0
  s_cmp_eq_u32 s50, 1
  s_cselect_b32 s10, s10, s94
  s_lshl_b32 s13, s11, 2
  s_add_u32 s13, s13, s10
  s_lshl_b32 s13, s13, 1
  s_add_u32 s13, s13, s4
  s_lshl_b32 s13, s13, 10
  s_add_u32 s13, s13, 4194304
  s_lshl_b32 s50, s50, 3
  v_cndmask_b32 v3, v53, v61, s[60:61]
  s_waitcnt vmcnt(3)
  buffer_load_dwordx4 v[220:223], v3, s[40:43], s57 offen offset:0 nt
  buffer_load_dwordx4 v[224:227], v3, s[40:43], s57 offen offset:128 nt
  buffer_load_dwordx4 v[228:231], v3, s[40:43], s57 offen offset:256 nt
  ds_read_b32 v6, v1 offset:44032
  s_waitcnt lgkmcnt(0)
  v_readfirstlane_b32 s92, v6
  s_mul_i32 s10, s92, 0x9e3779b1
  s_mul_hi_u32 s11, s92, 0x85ebca6b
  s_mul_i32 s12, s92, 0xc2b2ae35
  s_xor_b32 s11, s11, s12
  v_mov_b32 v44, s10
  v_mov_b32 v45, s11
  v_and_b32 v46, 1, v0
  v_cndmask_b32 v44, v44, v45, s[64:65]
  v_lshlrev_b32 v46, 4, v46
  v_lshrrev_b32 v44, v46, v44
  v_lshrrev_b32 v45, 4, v44
  v_lshrrev_b32 v46, 8, v44
  v_lshrrev_b32 v47, 12, v44
  v_cndmask_b32 v2, v54, v62, s[60:61]
  s_waitcnt vmcnt(3)
  buffer_load_dwordx4 v[232:235], v2, s[40:43], s57 offen offset:0 nt
  buffer_load_dwordx4 v[236:239], v2, s[40:43], s57 offen offset:128 nt
  buffer_load_dwordx4 v[240:243], v2, s[40:43], s57 offen offset:256 nt
  s_mov_b32 s62, 0
  s_mov_b32 s51, s95
  s_mov_b32 s12, 0x100000
L_sp8:
  ds_read_b32 v6, v1 offset:44080
  s_waitcnt lgkmcnt(0)
  v_readfirstlane_b32 s10, v6
  s_cmp_ge_u32 s10, 3
  s_cbranch_scc1 L_sd9
  s_sleep 1
  s_sub_u32 s12, s12, 1
  s_cbranch_scc0 L_sp8
  s_branch L_end
L_sd9:
  s_cmp_lg_u32 s3, 0
  s_cbranch_scc1 L_pg10
  s_memrealtime s[10:11]
  s_add_u32 s72, s72, 4
  v_mov_b32 v6, s72
  s_waitcnt lgkmcnt(0)
  s_or_b32 s10, s10, 1
  v_mov_b32 v7, s10
  ds_write_b32 v6, v7 offset:44288
L_pg10:
L_kq:
  ds_read_b128 v[8:11], v40 offset:42496
  ds_read_b128 v[12:15], v40 offset:42624
  ds_read_b128 v[16:19], v40 offset:42752
  v_add_u32 v40, 384, v40
  s_waitcnt lgkmcnt(0)
L_kloop:
  v_cndmask_b32 v3, v55, v63, s[60:61]
  s_waitcnt vmcnt(8)
  s_add_u32 s70, s70, s68
  s_cbranch_scc1 L_go11
  s_waitcnt vmcnt(5)
  s_add_u32 s71, s71, s69
  s_cbranch_scc0 L_go11
  s_waitcnt vmcnt(2)
L_go11:
  buffer_load_dwordx4 v[244:247], v3, s[40:43], s57 offen offset:0 nt
  buffer_load_dwordx4 v[248:251], v3, s[40:43], s57 offen offset:128 nt
  buffer_load_dwordx4 v[252:255], v3, s[40:43], s57 offen offset:256 nt
  v_dot2_f32_bf16 v20, v64, v8, 0
  v_dot2_f32_bf16 v20, v65, v9, v20
  v_dot2_f32_bf16 v20, v66, v10, v20
  v_dot2_f32_bf16 v20, v67, v11, v20
  v_dot2_f32_bf16 v20, v68, v12, v20
  v_dot2_f32_bf16 v20, v69, v13, v20
  v_dot2_f32_bf16 v20, v70, v14, v20
  v_dot2_f32_bf16 v20, v71, v15, v20
  v_dot2_f32_bf16 v20, v72, v16, v20
  v_dot2_f32_bf16 v20, v73, v17, v20
  v_dot2_f32_bf16 v20, v74, v18, v20
  v_dot2_f32_bf16 v20, v75, v19, v20
  s_add_u32 s58, s58, 1
  s_and_b32 s10, s58, 15
  s_cmp_lt_u32 s10, s26
  s_cselect_b32 s57, s0, s1
  s_add_u32 s57, s57, s10
  s_mul_i32 s57, s57, 196608
  s_cmp_eq_u32 s58, 16
  s_cselect_b32 s40, s20, s40
  s_cselect_b32 s41, s63, s41
  s_bitcmp1_b32 s59, s58
  s_cselect_b64 s[60:61], -1, 0
  v_cndmask_b32 v2, v48, v56, s[60:61]
  s_waitcnt vmcnt(8)
  s_add_u32 s70, s70, s68
  s_cbranch_scc1 L_go12
  s_waitcnt vmcnt(5)
  s_add_u32 s71, s71, s69
  s_cbranch_scc0 L_go12
  s_waitcnt vmcnt(2)
L_go12:
  buffer_load_dwordx4 v[64:67], v2, s[40:43], s57 offen offset:0 nt
  buffer_load_dwordx4 v[68:71], v2, s[40:43], s57 offen offset:128 nt
  buffer_load_dwordx4 v[72:75], v2, s[40:43], s57 offen offset:256 nt
  v_dot2_f32_bf16 v21, v76, v8, 0
  v_dot2_f32_bf16 v21, v77, v9, v21
  v_dot2_f32_bf16 v21, v78, v10, v21
  v_dot2_f32_bf16 v21, v79, v11, v21
  v_dot2_f32_bf16 v21, v80, v12, v21
  v_dot2_f32_bf16 v21, v81, v13, v21
  v_dot2_f32_bf16 v21, v82, v14, v21
  v_dot2_f32_bf16 v21, v83, v15, v21
  v_dot2_f32_bf16 v21, v84, v16, v21
  v_dot2_f32_bf16 v21, v85, v17, v21
  v_dot2_f32_bf16 v21, v86, v18, v21
  v_dot2_f32_bf16 v21, v87, v19, v21
  ds_read_b64 v[6:7], v1 offset:44072
  s_memrealtime s[74:75]
  v_cndmask_b32 v3, v49, v57, s[60:61]
  s_waitcnt vmcnt(8)
  s_add_u32 s70, s70, s68
  s_cbranch_scc1 L_go13
  s_waitcnt vmcnt(5)
  s_add_u32 s71, s71, s69
  s_cbranch_scc0 L_go13
  s_waitcnt vmcnt(2)
L_go13:
  buffer_load_dwordx4 v[76:79], v3, s[40:43], s57 offen offset:0 nt
  buffer_load_dwordx4 v[80:83], v3, s[40:43], s57 offen offset:128 nt
  buffer_load_dwordx4 v[84:87], v3, s[40:43], s57 offen offset:256 nt
  v_dot2_f32_bf16 v22, v88, v8, 0
  v_dot2_f32_bf16 v22, v89, v9, v22
  v_dot2_f32_bf16 v22, v90, v10, v22
  v_dot2_f32_bf16 v22, v91, v11, v22
  v_dot2_f32_bf16 v22, v92, v12, v22
  v_dot2_f32_bf16 v22, v93, v13, v22
  v_dot2_f32_bf16 v22, v94, v14, v22
  v_dot2_f32_bf16 v22, v95, v15, v22
  v_dot2_f32_bf16 v22, v96, v16, v22
  v_dot2_f32_bf16 v22, v97, v17, v22
  v_dot2_f32_bf16 v22, v98, v18, v22
  v_dot2_f32_bf16 v22, v99, v19, v22
  s_waitcnt lgkmcnt(0)
  v_readfirstlane_b32 s68, v6
  v_readfirstlane_b32 s69, v7
  s_lshl_b32 s10, s74, 5
  s_mul_i32 s11, s69, s93
  s_add_u32 s93, s93, 2
  s_sub_u32 s10, s10, s68
  s_sub_u32 s10, s10, s11
  s_cmp_eq_u32 s69, 0
  s_cselect_b32 s10, 0, s10
  s_min_i32 s10, s10, 4839
  s_max_i32 s10, s10, -3871
  s_max_i32 s68, s10, 0
  s_sub_i32 s69, 0, s10
  s_max_i32 s69, s69, 0
  s_mul_i32 s68, s68, 832000
  s_mul_i32 s69, s69, 832000
  v_cndmask_b32 v2, v50, v58, s[60:61]
  s_waitcnt vmcnt(8)
  s_add_u32 s70, s70, s68
  s_cbranch_scc1 L_go14
  s_waitcnt vmcnt(5)
  s_add_u32 s71, s71, s69
  s_cbranch_scc0 L_go14
  s_waitcnt vmcnt(2)
L_go14:
  buffer_load_dwordx4 v[88:91], v2, s[40:43], s57 offen offset:0 nt
  buffer_load_dwordx4 v[92:95], v2, s[40:43], s57 offen offset:128 nt
  buffer_load_dwordx4 v[96:99], v2, s[40:43], s57 offen offset:256 nt
  v_dot2_f32_bf16 v23, v100, v8, 0
  v_dot2_f32_bf16 v23, v101, v9, v23
  v_dot2_f32_bf16 v23, v102, v10, v23
  v_dot2_f32_bf16 v23, v103, v11, v23
  v_dot2_f32_bf16 v23, v104, v12, v23
  v_dot2_f32_bf16 v23, v105, v13, v23
  v_dot2_f32_bf16 v23, v106, v14, v23
  v_dot2_f32_bf16 v23, v107, v15, v23
  v_dot2_f32_bf16 v23, v108, v16, v23
  v_dot2_f32_bf16 v23, v109, v17, v23
  v_dot2_f32_bf16 v23, v110, v18, v23
  v_dot2_f32_bf16 v23, v111, v19, v23
  v_cndmask_b32 v3, v51, v59, s[60:61]
  s_waitcnt vmcnt(8)
  s_add_u32 s70, s70, s68
  s_cbranch_scc1 L_go15
  s_waitcnt vmcnt(5)
  s_add_u32 s71, s71, s69
  s_cbranch_scc0 L_go15
  s_waitcnt vmcnt(2)
L_go15:
  buffer_load_dwordx4 v[100:103], v3, s[40:43], s57 offen offset:0 nt
  buffer_load_dwordx4 v[104:107], v3, s[40:43], s57 offen offset:128 nt
  buffer_load_dwordx4 v[108:111], v3, s[40:43], s57 offen offset:256 nt
  v_dot2_f32_bf16 v24, v112, v8, 0
  v_dot2_f32_bf16 v24, v113, v9, v24
  v_dot2_f32_bf16 v24, v114, v10, v24
  v_dot2_f32_bf16 v24, v115, v11, v24
  v_dot2_f32_bf16 v24, v116, v12, v24
  v_dot2_f32_bf16 v24, v117, v13, v24
  v_dot2_f32_bf16 v24, v118, v14, v24
  v_dot2_f32_bf16 v24, v119, v15, v24
  v_dot2_f32_bf16 v24, v120, v16, v24
  v_dot2_f32_bf16 v24, v121, v17, v24
  v_dot2_f32_bf16 v24, v122, v18, v24
  v_dot2_f32_bf16 v24, v123, v19, v24
  v_cndmask_b32 v2, v52, v60, s[60:61]
  s_waitcnt vmcnt(8)
  s_add_u32 s70, s70, s68
  s_cbranch_scc1 L_go16
  s_waitcnt vmcnt(5)
  s_add_u32 s71, s71, s69
  s_cbranch_scc0 L_go16
  s_waitcnt vmcnt(2)
L_go16:
  buffer_load_dwordx4 v[112:115], v2, s[40:43], s57 offen offset:0 nt
  buffer_load_dwordx4 v[116:119], v2, s[40:43], s57 offen offset:128 nt
  buffer_load_dwordx4 v[120:123], v2, s[40:43], s57 offen offset:256 nt
  v_dot2_f32_bf16 v25, v124, v8, 0
  v_dot2_f32_bf16 v25, v125, v9, v25
  v_dot2_f32_bf16 v25, v126, v10, v25
  v_dot2_f32_bf16 v25, v127, v11, v25
  v_dot2_f32_bf16 v25, v128, v12, v25
  v_dot2_f32_bf16 v25, v129, v13, v25
  v_dot2_f32_bf16 v25, v130, v14, v25
  v_dot2_f32_bf16 v25, v131, v15, v25
  v_dot2_f32_bf16 v25, v132, v16, v25
  v_dot2_f32_bf16 v25, v133, v17, v25
  v_dot2_f32_bf16 v25, v134, v18, v25
  v_dot2_f32_bf16 v25, v135, v19, v25
  ds_read_b64 v[6:7], v1 offset:44072
  s_memrealtime s[74:75]
  v_cndmask_b32 v3, v53, v61, s[60:61]
  s_waitcnt vmcnt(8)
  s_add_u32 s70, s70, s68
  s_cbranch_scc1 L_go17
  s_waitcnt vmcnt(5)
  s_add_u32 s71, s71, s69
  s_cbranch_scc0 L_go17
  s_waitcnt vmcnt(2)
L_go17:
  buffer_load_dwordx4 v[124:127], v3, s[40:43], s57 offen offset:0 nt
  buffer_load_dwordx4 v[128:131], v3, s[40:43], s57 offen offset:128 nt
  buffer_load_dwordx4 v[132:135], v3, s[40:43], s57 offen offset:256 nt
  v_dot2_f32_bf16 v26, v136, v8, 0
  v_dot2_f32_bf16 v26, v137, v9, v26
  v_dot2_f32_bf16 v26, v138, v10, v26
  v_dot2_f32_bf16 v26, v139, v11, v26
  v_dot2_f32_bf16 v26, v140, v12, v26
  v_dot2_f32_bf16 v26, v141, v13, v26
  v_dot2_f32_bf16 v26, v142, v14, v26
  v_dot2_f32_bf16 v26, v143, v15, v26
  v_dot2_f32_bf16 v26, v144, v16, v26
  v_dot2_f32_bf16 v26, v145, v17, v26
  v_dot2_f32_bf16 v26, v146, v18, v26
  v_dot2_f32_bf16 v26, v147, v19, v26
  s_waitcnt lgkmcnt(0)
  v_readfirstlane_b32 s68, v6
  v_readfirstlane_b32 s69, v7
  s_lshl_b32 s10, s74, 5
  s_mul_i32 s11, s69, s93
  s_add_u32 s93, s93, 2
  s_sub_u32 s10, s10, s68
  s_sub_u32 s10, s10, s11
  s_cmp_eq_u32 s69, 0
  s_cselect_b32 s10, 0, s10
  s_min_i32 s10, s10, 4839
  s_max_i32 s10, s10, -3871
  s_max_i32 s68, s10, 0
  s_sub_i32 s69, 0, s10
  s_max_i32 s69, s69, 0
  s_mul_i32 s68, s68, 832000
  s_mul_i32 s69, s69, 832000
  v_cndmask_b32 v2, v54, v62, s[60:61]
  s_waitcnt vmcnt(8)
  s_add_u32 s70, s70, s68
  s_cbranch_scc1 L_go18
  s_waitcnt vmcnt(5)
  s_add_u32 s71, s71, s69
  s_cbranch_scc0 L_go18
  s_waitcnt vmcnt(2)
L_go18:
  buffer_load_dwordx4 v[136:139], v2, s[40:43], s57 offen offset:0 nt
  buffer_load_dwordx4 v[140:143], v2, s[40:43], s57 offen offset:128 nt
  buffer_load_dwordx4 v[144:147], v2, s[40:43], s57 offen offset:256 nt
  v_dot2_f32_bf16 v27, v148, v8, 0
  v_dot2_f32_bf16 v27, v149, v9, v27
  v_dot2_f32_bf16 v27, v150, v10, v27
  v_dot2_f32_bf16 v27, v151, v11, v27
  v_dot2_f32_bf16 v27, v152, v12, v27
  v_dot2_f32_bf16 v27, v153, v13, v27
  v_dot2_f32_bf16 v27, v154, v14, v27
  v_dot2_f32_bf16 v27, v155, v15, v27
  v_dot2_f32_bf16 v27, v156, v16, v27
  v_dot2_f32_bf16 v27, v157, v17, v27
  v_dot2_f32_bf16 v27, v158, v18, v27
  v_dot2_f32_bf16 v27, v159, v19, v27
  s_nop 2
  v_add_f32_dpp v20, v20, v20 row_shl:4 row_mask:0xf bank_mask:0x5
  v_add_f32_dpp v21, v21, v21 row_shl:4 row_mask:0xf bank_mask:0x5
  v_add_f32_dpp v22, v22, v22 row_shl:4 row_mask:0xf bank_mask:0x5
  v_add_f32_dpp v23, v23, v23 row_shl:4 row_mask:0xf bank_mask:0x5
  v_add_f32_dpp v20, v24, v24 row_shr:4 row_mask:0xf bank_mask:0xa
  v_add_f32_dpp v21, v25, v25 row_shr:4 row_mask:0xf bank_mask:0xa
  v_add_f32_dpp v22, v26, v26 row_shr:4 row_mask:0xf bank_mask:0xa
  v_add_f32_dpp v23, v27, v27 row_shr:4 row_mask:0xf bank_mask:0xa
  v_add_f32_dpp v24, v20, v20 quad_perm:[2,3,0,1] row_mask:0xf bank_mask:0xf
  v_add_f32_dpp v25, v21, v21 quad_perm:[2,3,0,1] row_mask:0xf bank_mask:0xf
  v_add_f32_dpp v26, v22, v22 quad_perm:[2,3,0,1] row_mask:0xf bank_mask:0xf
  v_add_f32_dpp v27, v23, v23 quad_perm:[2,3,0,1] row_mask:0xf bank_mask:0xf
  v_cndmask_b32 v20, v24, v26, s[64:65]
  v_cndmask_b32 v21, v25, v27, s[64:65]
  s_nop 0
  v_add_f32_dpp v24, v20, v20 quad_perm:[1,0,3,2] row_mask:0xf bank_mask:0xf
  v_add_f32_dpp v25, v21, v21 quad_perm:[1,0,3,2] row_mask:0xf bank_mask:0xf
  v_cndmask_b32 v28, v24, v25, s[66:67]
  v_cvt_pk_bf16_f32 v28, v28, v28
  v_lshlrev_b32 v28, 16, v28
  v_mul_f32 v28, 0x3d93cd3a, v28
  v_cvt_pk_bf16_f32 v28, v28, v28
  ds_write_b16 v4, v28 offset:0
  s_cmp_lg_u32 s3, 0
  s_cbranch_scc1 L_pg19
  s_memrealtime s[10:11]
  s_add_u32 s72, s72, 4
  v_mov_b32 v6, s72
  s_waitcnt lgkmcnt(0)
  s_or_b32 s10, s10, 1
  v_mov_b32 v7, s10
  ds_write_b32 v6, v7 offset:44288
L_pg19:
  v_cndmask_b32 v3, v55, v63, s[60:61]
  s_waitcnt vmcnt(8)
  s_add_u32 s70, s70, s68
  s_cbranch_scc1 L_go20
  s_waitcnt vmcnt(5)
  s_add_u32 s71, s71, s69
  s_cbranch_scc0 L_go20
  s_waitcnt vmcnt(2)
L_go20:
  buffer_load_dwordx4 v[148:151], v3, s[40:43], s57 offen offset:0 nt
  buffer_load_dwordx4 v[152:155], v3, s[40:43], s57 offen offset:128 nt
  buffer_load_dwordx4 v[156:159], v3, s[40:43], s57 offen offset:256 nt
  s_bitcmp1_b32 s51, 0
  s_cbranch_scc0 L_mb21
  ds_read_b128 v[8:11], v40 offset:42496
  ds_read_b128 v[12:15], v40 offset:42624
  ds_read_b128 v[16:19], v40 offset:42752
  v_add_u32 v40, 384, v40
  s_waitcnt lgkmcnt(0)
L_mb21:
  v_dot2_f32_bf16 v20, v160, v8, 0
  v_dot2_f32_bf16 v20, v161, v9, v20
  v_dot2_f32_bf16 v20, v162, v10, v20
  v_dot2_f32_bf16 v20, v163, v11, v20
  v_dot2_f32_bf16 v20, v164, v12, v20
  v_dot2_f32_bf16 v20, v165, v13, v20
  v_dot2_f32_bf16 v20, v166, v14, v20
  v_dot2_f32_bf16 v20, v167, v15, v20
  v_dot2_f32_bf16 v20, v168, v16, v20
  v_dot2_f32_bf16 v20, v169, v17, v20
  v_dot2_f32_bf16 v20, v170, v18, v20
  v_dot2_f32_bf16 v20, v171, v19, v20
  s_add_u32 s58, s58, 1
  s_and_b32 s10, s58, 15
  s_cmp_lt_u32 s10, s26
  s_cselect_b32 s57, s0, s1
  s_add_u32 s57, s57, s10
  s_mul_i32 s57, s57, 196608
  s_bitcmp1_b32 s59, s58
  s_cselect_b64 s[60:61], -1, 0
  v_cndmask_b32 v2, v48, v56, s[60:61]
  s_waitcnt vmcnt(8)
  s_add_u32 s70, s70, s68
  s_cbranch_scc1 L_go22
  s_waitcnt vmcnt(5)
  s_add_u32 s71, s71, s69
  s_cbranch_scc0 L_go22
  s_waitcnt vmcnt(2)
L_go22:
  buffer_load_dwordx4 v[160:163], v2, s[40:43], s57 offen offset:0 nt
  buffer_load_dwordx4 v[164:167], v2, s[40:43], s57 offen offset:128 nt
  buffer_load_dwordx4 v[168:171], v2, s[40:43], s57 offen offset:256 nt
  v_dot2_f32_bf16 v21, v172, v8, 0
  v_dot2_f32_bf16 v21, v173, v9, v21
  v_dot2_f32_bf16 v21, v174, v10, v21
  v_dot2_f32_bf16 v21, v175, v11, v21
  v_dot2_f32_bf16 v21, v176, v12, v21
  v_dot2_f32_bf16 v21, v177, v13, v21
  v_dot2_f32_bf16 v21, v178, v14, v21
  v_dot2_f32_bf16 v21, v179, v15, v21
  v_dot2_f32_bf16 v21, v180, v16, v21
  v_dot2_f32_bf16 v21, v181, v17, v21
  v_dot2_f32_bf16 v21, v182, v18, v21
  v_dot2_f32_bf16 v21, v183, v19, v21
  ds_read_b64 v[6:7], v1 offset:44072
  s_memrealtime s[74:75]
  v_cndmask_b32 v3, v49, v57, s[60:61]
  s_waitcnt vmcnt(8)
  s_add_u32 s70, s70, s68
  s_cbranch_scc1 L_go23
  s_waitcnt vmcnt(5)
  s_add_u32 s71, s71, s69
  s_cbranch_scc0 L_go23
  s_waitcnt vmcnt(2)
L_go23:
  buffer_load_dwordx4 v[172:175], v3, s[40:43], s57 offen offset:0 nt
  buffer_load_dwordx4 v[176:179], v3, s[40:43], s57 offen offset:128 nt
  buffer_load_dwordx4 v[180:183], v3, s[40:43], s57 offen offset:256 nt
  v_dot2_f32_bf16 v22, v184, v8, 0
  v_dot2_f32_bf16 v22, v185, v9, v22
  v_dot2_f32_bf16 v22, v186, v10, v22
  v_dot2_f32_bf16 v22, v187, v11, v22
  v_dot2_f32_bf16 v22, v188, v12, v22
  v_dot2_f32_bf16 v22, v189, v13, v22
  v_dot2_f32_bf16 v22, v190, v14, v22
  v_dot2_f32_bf16 v22, v191, v15, v22
  v_dot2_f32_bf16 v22, v192, v16, v22
  v_dot2_f32_bf16 v22, v193, v17, v22
  v_dot2_f32_bf16 v22, v194, v18, v22
  v_dot2_f32_bf16 v22, v195, v19, v22
  s_waitcnt lgkmcnt(0)
  v_readfirstlane_b32 s68, v6
  v_readfirstlane_b32 s69, v7
  s_lshl_b32 s10, s74, 5
  s_mul_i32 s11, s69, s93
  s_add_u32 s93, s93, 2
  s_sub_u32 s10, s10, s68
  s_sub_u32 s10, s10, s11
  s_cmp_eq_u32 s69, 0
  s_cselect_b32 s10, 0, s10
  s_min_i32 s10, s10, 4839
  s_max_i32 s10, s10, -3871
  s_max_i32 s68, s10, 0
  s_sub_i32 s69, 0, s10
  s_max_i32 s69, s69, 0
  s_mul_i32 s68, s68, 832000
  s_mul_i32 s69, s69, 832000
  v_cndmask_b32 v2, v50, v58, s[60:61]
  s_waitcnt vmcnt(8)
  s_add_u32 s70, s70, s68
  s_cbranch_scc1 L_go24
  s_waitcnt vmcnt(5)
  s_add_u32 s71, s71, s69
  s_cbranch_scc0 L_go24
  s_waitcnt vmcnt(2)
L_go24:
  buffer_load_dwordx4 v[184:187], v2, s[40:43], s57 offen offset:0 nt
  buffer_load_dwordx4 v[188:191], v2, s[40:43], s57 offen offset:128 nt
  buffer_load_dwordx4 v[192:195], v2, s[40:43], s57 offen offset:256 nt
  v_dot2_f32_bf16 v23, v196, v8, 0
  v_dot2_f32_bf16 v23, v197, v9, v23
  v_dot2_f32_bf16 v23, v198, v10, v23
  v_dot2_f32_bf16 v23, v199, v11, v23
  v_dot2_f32_bf16 v23, v200, v12, v23
  v_dot2_f32_bf16 v23, v201, v13, v23
  v_dot2_f32_bf16 v23, v202, v14, v23
  v_dot2_f32_bf16 v23, v203, v15, v23
  v_dot2_f32_bf16 v23, v204, v16, v23
  v_dot2_f32_bf16 v23, v205, v17, v23
  v_dot2_f32_bf16 v23, v206, v18, v23
  v_dot2_f32_bf16 v23, v207, v19, v23
  v_cndmask_b32 v3, v51, v59, s[60:61]
  s_waitcnt vmcnt(8)
  s_add_u32 s70, s70, s68
  s_cbranch_scc1 L_go25
  s_waitcnt vmcnt(5)
  s_add_u32 s71, s71, s69
  s_cbranch_scc0 L_go25
  s_waitcnt vmcnt(2)
L_go25:
  buffer_load_dwordx4 v[196:199], v3, s[40:43], s57 offen offset:0 nt
  buffer_load_dwordx4 v[200:203], v3, s[40:43], s57 offen offset:128 nt
  buffer_load_dwordx4 v[204:207], v3, s[40:43], s57 offen offset:256 nt
  v_dot2_f32_bf16 v24, v208, v8, 0
  v_dot2_f32_bf16 v24, v209, v9, v24
  v_dot2_f32_bf16 v24, v210, v10, v24
  v_dot2_f32_bf16 v24, v211, v11, v24
  v_dot2_f32_bf16 v24, v212, v12, v24
  v_dot2_f32_bf16 v24, v213, v13, v24
  v_dot2_f32_bf16 v24, v214, v14, v24
  v_dot2_f32_bf16 v24, v215, v15, v24
  v_dot2_f32_bf16 v24, v216, v16, v24
  v_dot2_f32_bf16 v24, v217, v17, v24
  v_dot2_f32_bf16 v24, v218, v18, v24
  v_dot2_f32_bf16 v24, v219, v19, v24
  v_cndmask_b32 v2, v52, v60, s[60:61]
  s_waitcnt vmcnt(8)
  s_add_u32 s70, s70, s68
  s_cbranch_scc1 L_go26
  s_waitcnt vmcnt(5)
  s_add_u32 s71, s71, s69
  s_cbranch_scc0 L_go26
  s_waitcnt vmcnt(2)
L_go26:
  buffer_load_dwordx4 v[208:211], v2, s[40:43], s57 offen offset:0 nt
  buffer_load_dwordx4 v[212:215], v2, s[40:43], s57 offen offset:128 nt
  buffer_load_dwordx4 v[216:219], v2, s[40:43], s57 offen offset:256 nt
  v_dot2_f32_bf16 v25, v220, v8, 0
  v_dot2_f32_bf16 v25, v221, v9, v25
  v_dot2_f32_bf16 v25, v222, v10, v25
  v_dot2_f32_bf16 v25, v223, v11, v25
  v_dot2_f32_bf16 v25, v224, v12, v25
  v_dot2_f32_bf16 v25, v225, v13, v25
  v_dot2_f32_bf16 v25, v226, v14, v25
  v_dot2_f32_bf16 v25, v227, v15, v25
  v_dot2_f32_bf16 v25, v228, v16, v25
  v_dot2_f32_bf16 v25, v229, v17, v25
  v_dot2_f32_bf16 v25, v230, v18, v25
  v_dot2_f32_bf16 v25, v231, v19, v25
  ds_read_b64 v[6:7], v1 offset:44072
  s_memrealtime s[74:75]
  v_cndmask_b32 v3, v53, v61, s[60:61]
  s_waitcnt vmcnt(8)
  s_add_u32 s70, s70, s68
  s_cbranch_scc1 L_go27
  s_waitcnt vmcnt(5)
  s_add_u32 s71, s71, s69
  s_cbranch_scc0 L_go27
  s_waitcnt vmcnt(2)
L_go27:
  buffer_load_dwordx4 v[220:223], v3, s[40:43], s57 offen offset:0 nt
  buffer_load_dwordx4 v[224:227], v3, s[40:43], s57 offen offset:128 nt
  buffer_load_dwordx4 v[228:231], v3, s[40:43], s57 offen offset:256 nt
  v_dot2_f32_bf16 v26, v232, v8, 0
  v_dot2_f32_bf16 v26, v233, v9, v26
  v_dot2_f32_bf16 v26, v234, v10, v26
  v_dot2_f32_bf16 v26, v235, v11, v26
  v_dot2_f32_bf16 v26, v236, v12, v26
  v_dot2_f32_bf16 v26, v237, v13, v26
  v_dot2_f32_bf16 v26, v238, v14, v26
  v_dot2_f32_bf16 v26, v239, v15, v26
  v_dot2_f32_bf16 v26, v240, v16, v26
  v_dot2_f32_bf16 v26, v241, v17, v26
  v_dot2_f32_bf16 v26, v242, v18, v26
  v_dot2_f32_bf16 v26, v243, v19, v26
  s_waitcnt lgkmcnt(0)
  v_readfirstlane_b32 s68, v6
  v_readfirstlane_b32 s69, v7
  s_lshl_b32 s10, s74, 5
  s_mul_i32 s11, s69, s93
  s_add_u32 s93, s93, 2
  s_sub_u32 s10, s10, s68
  s_sub_u32 s10, s10, s11
  s_cmp_eq_u32 s69, 0
  s_cselect_b32 s10, 0, s10
  s_min_i32 s10, s10, 4839
  s_max_i32 s10, s10, -3871
  s_max_i32 s68, s10, 0
  s_sub_i32 s69, 0, s10
  s_max_i32 s69, s69, 0
  s_mul_i32 s68, s68, 832000
  s_mul_i32 s69, s69, 832000
  v_cndmask_b32 v2, v54, v62, s[60:61]
  s_waitcnt vmcnt(8)
  s_add_u32 s70, s70, s68
  s_cbranch_scc1 L_go28
  s_waitcnt vmcnt(5)
  s_add_u32 s71, s71, s69
  s_cbranch_scc0 L_go28
  s_waitcnt vmcnt(2)
L_go28:
  buffer_load_dwordx4 v[232:235], v2, s[40:43], s57 offen offset:0 nt
  buffer_load_dwordx4 v[236:239], v2, s[40:43], s57 offen offset:128 nt
  buffer_load_dwordx4 v[240:243], v2, s[40:43], s57 offen offset:256 nt
  v_dot2_f32_bf16 v27, v244, v8, 0
  v_dot2_f32_bf16 v27, v245, v9, v27
  v_dot2_f32_bf16 v27, v246, v10, v27
  v_dot2_f32_bf16 v27, v247, v11, v27
  v_dot2_f32_bf16 v27, v248, v12, v27
  v_dot2_f32_bf16 v27, v249, v13, v27
  v_dot2_f32_bf16 v27, v250, v14, v27
  v_dot2_f32_bf16 v27, v251, v15, v27
  v_dot2_f32_bf16 v27, v252, v16, v27
  v_dot2_f32_bf16 v27, v253, v17, v27
  v_dot2_f32_bf16 v27, v254, v18, v27
  v_dot2_f32_bf16 v27, v255, v19, v27
  s_nop 2
  v_add_f32_dpp v20, v20, v20 row_shl:4 row_mask:0xf bank_mask:0x5
  v_add_f32_dpp v21, v21, v21 row_shl:4 row_mask:0xf bank_mask:0x5
  v_add_f32_dpp v22, v22, v22 row_shl:4 row_mask:0xf bank_mask:0x5
  v_add_f32_dpp v23, v23, v23 row_shl:4 row_mask:0xf bank_mask:0x5
  v_add_f32_dpp v20, v24, v24 row_shr:4 row_mask:0xf bank_mask:0xa
  v_add_f32_dpp v21, v25, v25 row_shr:4 row_mask:0xf bank_mask:0xa
  v_add_f32_dpp v22, v26, v26 row_shr:4 row_mask:0xf bank_mask:0xa
  v_add_f32_dpp v23, v27, v27 row_shr:4 row_mask:0xf bank_mask:0xa
  v_add_f32_dpp v24, v20, v20 quad_perm:[2,3,0,1] row_mask:0xf bank_mask:0xf
  v_add_f32_dpp v25, v21, v21 quad_perm:[2,3,0,1] row_mask:0xf bank_mask:0xf
  v_add_f32_dpp v26, v22, v22 quad_perm:[2,3,0,1] row_mask:0xf bank_mask:0xf
  v_add_f32_dpp v27, v23, v23 quad_perm:[2,3,0,1] row_mask:0xf bank_mask:0xf
  v_cndmask_b32 v20, v24, v26, s[64:65]
  v_cndmask_b32 v21, v25, v27, s[64:65]
  s_nop 0
  v_add_f32_dpp v24, v20, v20 quad_perm:[1,0,3,2] row_mask:0xf bank_mask:0xf
  v_add_f32_dpp v25, v21, v21 quad_perm:[1,0,3,2] row_mask:0xf bank_mask:0xf
  v_cndmask_b32 v28, v24, v25, s[66:67]
  v_cvt_pk_bf16_f32 v28, v28, v28
  v_lshlrev_b32 v28, 16, v28
  v_mul_f32 v28, 0x3d93cd3a, v28
  v_cvt_pk_bf16_f32 v28, v28, v28
  ds_write_b16 v4, v28 offset:512
  s_cmp_lg_u32 s3, 0
  s_cbranch_scc1 L_pg29
  s_memrealtime s[10:11]
  s_add_u32 s72, s72, 4
  v_mov_b32 v6, s72
  s_waitcnt lgkmcnt(0)
  s_or_b32 s10, s10, 1
  v_mov_b32 v7, s10
  ds_write_b32 v6, v7 offset:44288
L_pg29:
  v_add_u32 v4, 1024, v4
  s_add_u32 s62, s62, 1
  s_and_b32 s10, s62, 3
  s_cbranch_scc1 L_knoseg
  v_mov_b32 v7, s62
  s_mov_b64 exec, 1
  v_mov_b32 v5, 1
  ds_add_u32 v7, v5 offset:44108
  s_mov_b64 exec, -1
  s_cmp_eq_u32 s62, 8
  s_cbranch_scc1 L_kdone
L_knoseg:
  s_mov_b32 s10, s51
  s_lshr_b32 s51, s51, 2
  s_bitcmp1_b32 s10, 1
  s_cbranch_scc0 L_kloop
  s_branch L_kq
L_kdone:
  v_lshrrev_b32 v4, 3, v0
  v_lshlrev_b32 v4, 4, v4
  v_add_u32 v40, 12288, v42
  s_mov_b32 s62, 0
  s_mov_b32 s51, s95
  s_mov_b64 vcc, 0
  v_mov_b32 v8, 0
  v_mov_b32 v9, 0
  v_mov_b32 v10, 0
  v_mov_b32 v11, 0
  v_mov_b32 v12, 0
  v_mov_b32 v13, 0
  v_mov_b32 v14, 0
  v_mov_b32 v15, 0
  v_mov_b32 v16, 0
  v_mov_b32 v17, 0
  v_mov_b32 v18, 0
  v_mov_b32 v19, 0
  s_mov_b32 s12, 0x100000
L_sp30:
  ds_read_b32 v6, v1 offset:44052
  s_waitcnt lgkmcnt(0)
  v_readfirstlane_b32 s10, v6
  s_cmp_ge_u32 s10, 4
  s_cbranch_scc1 L_sd31
  s_sleep 1
  s_sub_u32 s12, s12, 1
  s_cbranch_scc0 L_sp30
  s_branch L_end
L_sd31:
L_vloop:
  ds_read_b128 v[28:31], v4 offset:8192
  v_cndmask_b32 v3, v55, v63, s[60:61]
  s_waitcnt vmcnt(8)
  s_add_u32 s70, s70, s68
  s_cbranch_scc1 L_go32
  s_waitcnt vmcnt(5)
  s_add_u32 s71, s71, s69
  s_cbranch_scc0 L_go32
  s_waitcnt vmcnt(2)
L_go32:
  buffer_load_dwordx4 v[244:247], v3, s[40:43], s57 offen offset:0 nt
  buffer_load_dwordx4 v[248:251], v3, s[40:43], s57 offen offset:128 nt
  buffer_load_dwordx4 v[252:255], v3, s[40:43], s57 offen offset:256 nt
L_cons0:
  s_waitcnt lgkmcnt(0)
  v_perm_b32 v20, v28, v28, v32
  v_perm_b32 v21, v28, v28, v33
  v_perm_b32 v22, v28, v28, v34
  v_perm_b32 v23, v28, v28, v35
  s_nop 1
  v_mfma_f32_16x16x32_bf16 v[8:11], v[20:23], v[64:67], v[8:11]
  v_mfma_f32_16x16x32_bf16 v[12:15], v[20:23], v[68:71], v[12:15]
  v_mfma_f32_16x16x32_bf16 v[16:19], v[20:23], v[72:75], v[16:19]
  s_cbranch_vccnz L_dr1
  s_add_u32 s58, s58, 1
  s_and_b32 s10, s58, 15
  s_cmp_lt_u32 s10, s26
  s_cselect_b32 s57, s0, s1
  s_add_u32 s57, s57, s10
  s_mul_i32 s57, s57, 196608
  s_cmp_eq_u32 s58, 16
  s_cselect_b32 s40, s20, s40
  s_cselect_b32 s41, s63, s41
  s_bitcmp1_b32 s59, s58
  s_cselect_b64 s[60:61], -1, 0
  v_cndmask_b32 v2, v48, v56, s[60:61]
  s_waitcnt vmcnt(8)
  s_add_u32 s70, s70, s68
  s_cbranch_scc1 L_go33
  s_waitcnt vmcnt(5)
  s_add_u32 s71, s71, s69
  s_cbranch_scc0 L_go33
  s_waitcnt vmcnt(2)
L_go33:
  buffer_load_dwordx4 v[64:67], v2, s[40:43], s57 offen offset:0 nt
  buffer_load_dwordx4 v[68:71], v2, s[40:43], s57 offen offset:128 nt
  buffer_load_dwordx4 v[72:75], v2, s[40:43], s57 offen offset:256 nt
L_cons1:
  v_perm_b32 v24, v28, v28, v36
  v_perm_b32 v25, v28, v28, v37
  v_perm_b32 v26, v28, v28, v38
  v_perm_b32 v27, v28, v28, v39
  s_nop 1
  v_mfma_f32_16x16x32_bf16 v[8:11], v[24:27], v[76:79], v[8:11]
  v_mfma_f32_16x16x32_bf16 v[12:15], v[24:27], v[80:83], v[12:15]
  v_mfma_f32_16x16x32_bf16 v[16:19], v[24:27], v[84:87], v[16:19]
  s_cbranch_vccnz L_cons2
  ds_read_b64 v[6:7], v1 offset:44072
  s_memrealtime s[74:75]
  v_cndmask_b32 v3, v49, v57, s[60:61]
  s_waitcnt vmcnt(8)
  s_add_u32 s70, s70, s68
  s_cbranch_scc1 L_go34
  s_waitcnt vmcnt(5)
  s_add_u32 s71, s71, s69
  s_cbranch_scc0 L_go34
  s_waitcnt vmcnt(2)
L_go34:
  buffer_load_dwordx4 v[76:79], v3, s[40:43], s57 offen offset:0 nt
  buffer_load_dwordx4 v[80:83], v3, s[40:43], s57 offen offset:128 nt
  buffer_load_dwordx4 v[84:87], v3, s[40:43], s57 offen offset:256 nt
L_cons2:
  v_perm_b32 v20, v29, v29, v32
  v_perm_b32 v21, v29, v29, v33
  v_perm_b32 v22, v29, v29, v34
  v_perm_b32 v23, v29, v29, v35
  s_nop 1
  v_mfma_f32_16x16x32_bf16 v[8:11], v[20:23], v[88:91], v[8:11]
  v_mfma_f32_16x16x32_bf16 v[12:15], v[20:23], v[92:95], v[12:15]
  v_mfma_f32_16x16x32_bf16 v[16:19], v[20:23], v[96:99], v[16:19]
  s_cbranch_vccnz L_cons3
  s_waitcnt lgkmcnt(0)
  v_readfirstlane_b32 s68, v6
  v_readfirstlane_b32 s69, v7
  s_lshl_b32 s10, s74, 5
  s_mul_i32 s11, s69, s93
  s_add_u32 s93, s93, 2
  s_sub_u32 s10, s10, s68
  s_sub_u32 s10, s10, s11
  s_cmp_eq_u32 s69, 0
  s_cselect_b32 s10, 0, s10
  s_min_i32 s10, s10, 4839
  s_max_i32 s10, s10, -3871
  s_max_i32 s68, s10, 0
  s_sub_i32 s69, 0, s10
  s_max_i32 s69, s69, 0
  s_mul_i32 s68, s68, 832000
  s_mul_i32 s69, s69, 832000
  v_cndmask_b32 v2, v50, v58, s[60:61]
  s_waitcnt vmcnt(8)
  s_add_u32 s70, s70, s68
  s_cbranch_scc1 L_go35
  s_waitcnt vmcnt(5)
  s_add_u32 s71, s71, s69
  s_cbranch_scc0 L_go35
  s_waitcnt vmcnt(2)
L_go35:
  buffer_load_dwordx4 v[88:91], v2, s[40:43], s57 offen offset:0 nt
  buffer_load_dwordx4 v[92:95], v2, s[40:43], s57 offen offset:128 nt
  buffer_load_dwordx4 v[96:99], v2, s[40:43], s57 offen offset:256 nt
L_cons3:
  v_perm_b32 v24, v29, v29, v36
  v_perm_b32 v25, v29, v29, v37
  v_perm_b32 v26, v29, v29, v38
  v_perm_b32 v27, v29, v29, v39
  s_nop 1
  v_mfma_f32_16x16x32_bf16 v[8:11], v[24:27], v[100:103], v[8:11]
  v_mfma_f32_16x16x32_bf16 v[12:15], v[24:27], v[104:107], v[12:15]
  v_mfma_f32_16x16x32_bf16 v[16:19], v[24:27], v[108:111], v[16:19]
  s_cbranch_vccnz L_cons4
  v_cndmask_b32 v3, v51, v59, s[60:61]
  s_waitcnt vmcnt(8)
  s_add_u32 s70, s70, s68
  s_cbranch_scc1 L_go36
  s_waitcnt vmcnt(5)
  s_add_u32 s71, s71, s69
  s_cbranch_scc0 L_go36
  s_waitcnt vmcnt(2)
L_go36:
  buffer_load_dwordx4 v[100:103], v3, s[40:43], s57 offen offset:0 nt
  buffer_load_dwordx4 v[104:107], v3, s[40:43], s57 offen offset:128 nt
  buffer_load_dwordx4 v[108:111], v3, s[40:43], s57 offen offset:256 nt
L_cons4:
  v_perm_b32 v20, v30, v30, v32
  v_perm_b32 v21, v30, v30, v33
  v_perm_b32 v22, v30, v30, v34
  v_perm_b32 v23, v30, v30, v35
  s_nop 1
  v_mfma_f32_16x16x32_bf16 v[8:11], v[20:23], v[112:115], v[8:11]
  v_mfma_f32_16x16x32_bf16 v[12:15], v[20:23], v[116:119], v[12:15]
  v_mfma_f32_16x16x32_bf16 v[16:19], v[20:23], v[120:123], v[16:19]
  s_cbranch_vccnz L_cons5
  v_cndmask_b32 v2, v52, v60, s[60:61]
  s_waitcnt vmcnt(8)
  s_add_u32 s70, s70, s68
  s_cbranch_scc1 L_go37
  s_waitcnt vmcnt(5)
  s_add_u32 s71, s71, s69
  s_cbranch_scc0 L_go37
  s_waitcnt vmcnt(2)
L_go37:
  buffer_load_dwordx4 v[112:115], v2, s[40:43], s57 offen offset:0 nt
  buffer_load_dwordx4 v[116:119], v2, s[40:43], s57 offen offset:128 nt
  buffer_load_dwordx4 v[120:123], v2, s[40:43], s57 offen offset:256 nt
L_cons5:
  v_perm_b32 v24, v30, v30, v36
  v_perm_b32 v25, v30, v30, v37
  v_perm_b32 v26, v30, v30, v38
  v_perm_b32 v27, v30, v30, v39
  s_nop 1
  v_mfma_f32_16x16x32_bf16 v[8:11], v[24:27], v[124:127], v[8:11]
  v_mfma_f32_16x16x32_bf16 v[12:15], v[24:27], v[128:131], v[12:15]
  v_mfma_f32_16x16x32_bf16 v[16:19], v[24:27], v[132:135], v[16:19]
  s_cbranch_vccnz L_cons6
  ds_read_b64 v[6:7], v1 offset:44072
  s_memrealtime s[74:75]
  v_cndmask_b32 v3, v53, v61, s[60:61]
  s_waitcnt vmcnt(8)
  s_add_u32 s70, s70, s68
  s_cbranch_scc1 L_go38
  s_waitcnt vmcnt(5)
  s_add_u32 s71, s71, s69
  s_cbranch_scc0 L_go38
  s_waitcnt vmcnt(2)
L_go38:
  buffer_load_dwordx4 v[124:127], v3, s[40:43], s57 offen offset:0 nt
  buffer_load_dwordx4 v[128:131], v3, s[40:43], s57 offen offset:128 nt
  buffer_load_dwordx4 v[132:135], v3, s[40:43], s57 offen offset:256 nt
L_cons6:
  v_perm_b32 v20, v31, v31, v32
  v_perm_b32 v21, v31, v31, v33
  v_perm_b32 v22, v31, v31, v34
  v_perm_b32 v23, v31, v31, v35
  s_nop 1
  v_mfma_f32_16x16x32_bf16 v[8:11], v[20:23], v[136:139], v[8:11]
  v_mfma_f32_16x16x32_bf16 v[12:15], v[20:23], v[140:143], v[12:15]
  v_mfma_f32_16x16x32_bf16 v[16:19], v[20:23], v[144:147], v[16:19]
  s_cbranch_vccnz L_cons7
  s_waitcnt lgkmcnt(0)
  v_readfirstlane_b32 s68, v6
  v_readfirstlane_b32 s69, v7
  s_lshl_b32 s10, s74, 5
  s_mul_i32 s11, s69, s93
  s_add_u32 s93, s93, 2
  s_sub_u32 s10, s10, s68
  s_sub_u32 s10, s10, s11
  s_cmp_eq_u32 s69, 0
  s_cselect_b32 s10, 0, s10
  s_min_i32 s10, s10, 4839
  s_max_i32 s10, s10, -3871
  s_max_i32 s68, s10, 0
  s_sub_i32 s69, 0, s10
  s_max_i32 s69, s69, 0
  s_mul_i32 s68, s68, 832000
  s_mul_i32 s69, s69, 832000
  v_cndmask_b32 v2, v54, v62, s[60:61]
  s_waitcnt vmcnt(8)
  s_add_u32 s70, s70, s68
  s_cbranch_scc1 L_go39
  s_waitcnt vmcnt(5)
  s_add_u32 s71, s71, s69
  s_cbranch_scc0 L_go39
  s_waitcnt vmcnt(2)
L_go39:
  buffer_load_dwordx4 v[136:139], v2, s[40:43], s57 offen offset:0 nt
  buffer_load_dwordx4 v[140:143], v2, s[40:43], s57 offen offset:128 nt
  buffer_load_dwordx4 v[144:147], v2, s[40:43], s57 offen offset:256 nt
L_cons7:
  v_perm_b32 v24, v31, v31, v36
  v_perm_b32 v25, v31, v31, v37
  v_perm_b32 v26, v31, v31, v38
  v_perm_b32 v27, v31, v31, v39
  s_nop 1
  v_mfma_f32_16x16x32_bf16 v[8:11], v[24:27], v[148:151], v[8:11]
  v_mfma_f32_16x16x32_bf16 v[12:15], v[24:27], v[152:155], v[12:15]
  v_mfma_f32_16x16x32_bf16 v[16:19], v[24:27], v[156:159], v[16:19]
  ds_read_b128 v[28:31], v4 offset:8704
  s_cbranch_vccnz L_cons8
  s_cmp_lg_u32 s3, 0
  s_cbranch_scc1 L_pg40
  s_memrealtime s[10:11]
  s_add_u32 s72, s72, 4
  v_mov_b32 v6, s72
  s_waitcnt lgkmcnt(0)
  s_or_b32 s10, s10, 1
  v_mov_b32 v7, s10
  ds_write_b32 v6, v7 offset:44288
L_pg40:
  v_cndmask_b32 v3, v55, v63, s[60:61]
  s_waitcnt vmcnt(8)
  s_add_u32 s70, s70, s68
  s_cbranch_scc1 L_go41
  s_waitcnt vmcnt(5)
  s_add_u32 s71, s71, s69
  s_cbranch_scc0 L_go41
  s_waitcnt vmcnt(2)
L_go41:
  buffer_load_dwordx4 v[148:151], v3, s[40:43], s57 offen offset:0 nt
  buffer_load_dwordx4 v[152:155], v3, s[40:43], s57 offen offset:128 nt
  buffer_load_dwordx4 v[156:159], v3, s[40:43], s57 offen offset:256 nt
  s_bitcmp1_b32 s51, 0
  s_cbranch_scc0 L_mb42
  s_mov_b32 exec_lo, 0x00ff00ff
  s_mov_b32 exec_hi, 0xff00ff00
  s_nop 5
  ds_write_b128 v41, v[8:11] offset:16384
  ds_write_b128 v41, v[12:15] offset:16640
  ds_write_b128 v41, v[16:19] offset:16896
  s_mov_b64 exec, 1
  v_mov_b32 v5, 1
  ds_add_u32 v43, v5 offset:44096
  s_mov_b64 exec, -1
  v_add_u32 v41, 6144, v41
  v_add_u32 v43, 4, v43
  v_mov_b32 v8, 0
  v_mov_b32 v9, 0
  v_mov_b32 v10, 0
  v_mov_b32 v11, 0
  v_mov_b32 v12, 0
  v_mov_b32 v13, 0
  v_mov_b32 v14, 0
  v_mov_b32 v15, 0
  v_mov_b32 v16, 0
  v_mov_b32 v17, 0
  v_mov_b32 v18, 0
  v_mov_b32 v19, 0
L_mb42:
L_cons8:
  s_waitcnt lgkmcnt(0)
  v_perm_b32 v20, v28, v28, v32
  v_perm_b32 v21, v28, v28, v33
  v_perm_b32 v22, v28, v28, v34
  v_perm_b32 v23, v28, v28, v35
  s_nop 1
  v_mfma_f32_16x16x32_bf16 v[8:11], v[20:23], v[160:163], v[8:11]
  v_mfma_f32_16x16x32_bf16 v[12:15], v[20:23], v[164:167], v[12:15]
  v_mfma_f32_16x16x32_bf16 v[16:19], v[20:23], v[168:171], v[16:19]
  s_cbranch_vccnz L_cons9
  s_add_u32 s58, s58, 1
  s_and_b32 s10, s58, 15
  s_cmp_lt_u32 s10, s26
  s_cselect_b32 s57, s0, s1
  s_add_u32 s57, s57, s10
  s_mul_i32 s57, s57, 196608
  s_bitcmp1_b32 s59, s58
  s_cselect_b64 s[60:61], -1, 0
  v_cndmask_b32 v2, v48, v56, s[60:61]
  s_waitcnt vmcnt(8)
  s_add_u32 s70, s70, s68
  s_cbranch_scc1 L_go43
  s_waitcnt vmcnt(5)
  s_add_u32 s71, s71, s69
  s_cbranch_scc0 L_go43
  s_waitcnt vmcnt(2)
L_go43:
  buffer_load_dwordx4 v[160:163], v2, s[40:43], s57 offen offset:0 nt
  buffer_load_dwordx4 v[164:167], v2, s[40:43], s57 offen offset:128 nt
  buffer_load_dwordx4 v[168:171], v2, s[40:43], s57 offen offset:256 nt
L_cons9:
  v_perm_b32 v24, v28, v28, v36
  v_perm_b32 v25, v28, v28, v37
  v_perm_b32 v26, v28, v28, v38
  v_perm_b32 v27, v28, v28, v39
  s_nop 1
  v_mfma_f32_16x16x32_bf16 v[8:11], v[24:27], v[172:175], v[8:11]
  v_mfma_f32_16x16x32_bf16 v[12:15], v[24:27], v[176:179], v[12:15]
  v_mfma_f32_16x16x32_bf16 v[16:19], v[24:27], v[180:183], v[16:19]
  s_cbranch_vccnz L_cons10
  ds_read_b64 v[6:7], v1 offset:44072
  s_memrealtime s[74:75]
  v_cndmask_b32 v3, v49, v57, s[60:61]
  s_waitcnt vmcnt(8)
  s_add_u32 s70, s70, s68
  s_cbranch_scc1 L_go44
  s_waitcnt vmcnt(5)
  s_add_u32 s71, s71, s69
  s_cbranch_scc0 L_go44
  s_waitcnt vmcnt(2)
L_go44:
  buffer_load_dwordx4 v[172:175], v3, s[40:43], s57 offen offset:0 nt
  buffer_load_dwordx4 v[176:179], v3, s[40:43], s57 offen offset:128 nt
  buffer_load_dwordx4 v[180:183], v3, s[40:43], s57 offen offset:256 nt
L_cons10:
  v_perm_b32 v20, v29, v29, v32
  v_perm_b32 v21, v29, v29, v33
  v_perm_b32 v22, v29, v29, v34
  v_perm_b32 v23, v29, v29, v35
  s_nop 1
  v_mfma_f32_16x16x32_bf16 v[8:11], v[20:23], v[184:187], v[8:11]
  v_mfma_f32_16x16x32_bf16 v[12:15], v[20:23], v[188:191], v[12:15]
  v_mfma_f32_16x16x32_bf16 v[16:19], v[20:23], v[192:195], v[16:19]
  s_cbranch_vccnz L_cons11
  s_waitcnt lgkmcnt(0)
  v_readfirstlane_b32 s68, v6
  v_readfirstlane_b32 s69, v7
  s_lshl_b32 s10, s74, 5
  s_mul_i32 s11, s69, s93
  s_add_u32 s93, s93, 2
  s_sub_u32 s10, s10, s68
  s_sub_u32 s10, s10, s11
  s_cmp_eq_u32 s69, 0
  s_cselect_b32 s10, 0, s10
  s_min_i32 s10, s10, 4839
  s_max_i32 s10, s10, -3871
  s_max_i32 s68, s10, 0
  s_sub_i32 s69, 0, s10
  s_max_i32 s69, s69, 0
  s_mul_i32 s68, s68, 832000
  s_mul_i32 s69, s69, 832000
  v_cndmask_b32 v2, v50, v58, s[60:61]
  s_waitcnt vmcnt(8)
  s_add_u32 s70, s70, s68
  s_cbranch_scc1 L_go45
  s_waitcnt vmcnt(5)
  s_add_u32 s71, s71, s69
  s_cbranch_scc0 L_go45
  s_waitcnt vmcnt(2)
L_go45:
  buffer_load_dwordx4 v[184:187], v2, s[40:43], s57 offen offset:0 nt
  buffer_load_dwordx4 v[188:191], v2, s[40:43], s57 offen offset:128 nt
  buffer_load_dwordx4 v[192:195], v2, s[40:43], s57 offen offset:256 nt
L_cons11:
  v_perm_b32 v24, v29, v29, v36
  v_perm_b32 v25, v29, v29, v37
  v_perm_b32 v26, v29, v29, v38
  v_perm_b32 v27, v29, v29, v39
  s_nop 1
  v_mfma_f32_16x16x32_bf16 v[8:11], v[24:27], v[196:199], v[8:11]
  v_mfma_f32_16x16x32_bf16 v[12:15], v[24:27], v[200:203], v[12:15]
  v_mfma_f32_16x16x32_bf16 v[16:19], v[24:27], v[204:207], v[16:19]
  s_cbranch_vccnz L_dr12
  v_cndmask_b32 v3, v51, v59, s[60:61]
  s_waitcnt vmcnt(8)
  s_add_u32 s70, s70, s68
  s_cbranch_scc1 L_go46
  s_waitcnt vmcnt(5)
  s_add_u32 s71, s71, s69
  s_cbranch_scc0 L_go46
  s_waitcnt vmcnt(2)
L_go46:
  buffer_load_dwordx4 v[196:199], v3, s[40:43], s57 offen offset:0 nt
  buffer_load_dwordx4 v[200:203], v3, s[40:43], s57 offen offset:128 nt
  buffer_load_dwordx4 v[204:207], v3, s[40:43], s57 offen offset:256 nt
L_cons12:
  v_perm_b32 v20, v30, v30, v32
  v_perm_b32 v21, v30, v30, v33
  v_perm_b32 v22, v30, v30, v34
  v_perm_b32 v23, v30, v30, v35
  s_nop 1
  v_mfma_f32_16x16x32_bf16 v[8:11], v[20:23], v[208:211], v[8:11]
  v_mfma_f32_16x16x32_bf16 v[12:15], v[20:23], v[212:215], v[12:15]
  v_mfma_f32_16x16x32_bf16 v[16:19], v[20:23], v[216:219], v[16:19]
  s_cbranch_vccnz L_dr13
  v_cndmask_b32 v2, v52, v60, s[60:61]
  s_waitcnt vmcnt(8)
  s_add_u32 s70, s70, s68
  s_cbranch_scc1 L_go47
  s_waitcnt vmcnt(5)
  s_add_u32 s71, s71, s69
  s_cbranch_scc0 L_go47
  s_waitcnt vmcnt(2)
L_go47:
  buffer_load_dwordx4 v[208:211], v2, s[40:43], s57 offen offset:0 nt
  buffer_load_dwordx4 v[212:215], v2, s[40:43], s57 offen offset:128 nt
  buffer_load_dwordx4 v[216:219], v2, s[40:43], s57 offen offset:256 nt
L_cons13:
  v_perm_b32 v24, v30, v30, v36
  v_perm_b32 v25, v30, v30, v37
  v_perm_b32 v26, v30, v30, v38
  v_perm_b32 v27, v30, v30, v39
  s_nop 1
  v_mfma_f32_16x16x32_bf16 v[8:11], v[24:27], v[220:223], v[8:11]
  v_mfma_f32_16x16x32_bf16 v[12:15], v[24:27], v[224:227], v[12:15]
  v_mfma_f32_16x16x32_bf16 v[16:19], v[24:27], v[228:231], v[16:19]
  s_cbranch_vccnz L_dr14
  ds_read_b64 v[6:7], v1 offset:44072
  s_memrealtime s[74:75]
  v_cndmask_b32 v3, v53, v61, s[60:61]
  s_waitcnt vmcnt(8)
  s_add_u32 s70, s70, s68
  s_cbranch_scc1 L_go48
  s_waitcnt vmcnt(5)
  s_add_u32 s71, s71, s69
  s_cbranch_scc0 L_go48
  s_waitcnt vmcnt(2)
L_go48:
  buffer_load_dwordx4 v[220:223], v3, s[40:43], s57 offen offset:0 nt
  buffer_load_dwordx4 v[224:227], v3, s[40:43], s57 offen offset:128 nt
  buffer_load_dwordx4 v[228:231], v3, s[40:43], s57 offen offset:256 nt
L_cons14:
  v_perm_b32 v20, v31, v31, v32
  v_perm_b32 v21, v31, v31, v33
  v_perm_b32 v22, v31, v31, v34
  v_perm_b32 v23, v31, v31, v35
  s_nop 1
  v_mfma_f32_16x16x32_bf16 v[8:11], v[20:23], v[232:235], v[8:11]
  v_mfma_f32_16x16x32_bf16 v[12:15], v[20:23], v[236:239], v[12:15]
  v_mfma_f32_16x16x32_bf16 v[16:19], v[20:23], v[240:243], v[16:19]
  s_cbranch_vccnz L_dr15
  s_waitcnt lgkmcnt(0)
  v_readfirstlane_b32 s68, v6
  v_readfirstlane_b32 s69, v7
  s_lshl_b32 s10, s74, 5
  s_mul_i32 s11, s69, s93
  s_add_u32 s93, s93, 2
  s_sub_u32 s10, s10, s68
  s_sub_u32 s10, s10, s11
  s_cmp_eq_u32 s69, 0
  s_cselect_b32 s10, 0, s10
  s_min_i32 s10, s10, 4839
  s_max_i32 s10, s10, -3871
  s_max_i32 s68, s10, 0
  s_sub_i32 s69, 0, s10
  s_max_i32 s69, s69, 0
  s_mul_i32 s68, s68, 832000
  s_mul_i32 s69, s69, 832000
  v_cndmask_b32 v2, v54, v62, s[60:61]
  s_waitcnt vmcnt(8)
  s_add_u32 s70, s70, s68
  s_cbranch_scc1 L_go49
  s_waitcnt vmcnt(5)
  s_add_u32 s71, s71, s69
  s_cbranch_scc0 L_go49
  s_waitcnt vmcnt(2)
L_go49:
  buffer_load_dwordx4 v[232:235], v2, s[40:43], s57 offen offset:0 nt
  buffer_load_dwordx4 v[236:239], v2, s[40:43], s57 offen offset:128 nt
  buffer_load_dwordx4 v[240:243], v2, s[40:43], s57 offen offset:256 nt
L_cons15:
  v_perm_b32 v24, v31, v31, v36
  v_perm_b32 v25, v31, v31, v37
  v_perm_b32 v26, v31, v31, v38
  v_perm_b32 v27, v31, v31, v39
  s_nop 1
  v_mfma_f32_16x16x32_bf16 v[8:11], v[24:27], v[244:247], v[8:11]
  v_mfma_f32_16x16x32_bf16 v[12:15], v[24:27], v[248:251], v[12:15]
  v_mfma_f32_16x16x32_bf16 v[16:19], v[24:27], v[252:255], v[16:19]
  s_cbranch_vccnz L_vflush
  s_cmp_lg_u32 s3, 0
  s_cbranch_scc1 L_pg50
  s_memrealtime s[10:11]
  s_add_u32 s72, s72, 4
  v_mov_b32 v6, s72
  s_waitcnt lgkmcnt(0)
  s_or_b32 s10, s10, 1
  v_mov_b32 v7, s10
  ds_write_b32 v6, v7 offset:44288
L_pg50:
  v_add_u32 v4, 1024, v4
  s_add_u32 s62, s62, 1
  s_bitcmp1_b32 s51, 1
  s_cbranch_scc0 L_vnoflush
L_vflush:
  s_mov_b32 exec_lo, 0x00ff00ff
  s_mov_b32 exec_hi, 0xff00ff00
  s_nop 5
  ds_write_b128 v41, v[8:11] offset:16384
  ds_write_b128 v41, v[12:15] offset:16640
  ds_write_b128 v41, v[16:19] offset:16896
  s_mov_b64 exec, 1
  v_mov_b32 v5, 1
  ds_add_rtn_u32 v6, v43, v5 offset:44096
  s_waitcnt lgkmcnt(0)
  v_readfirstlane_b32 s10, v6
  s_mov_b64 exec, -1
  s_cbranch_vccnz L_vlast
  v_add_u32 v41, 6144, v41
  v_add_u32 v43, 4, v43
  v_mov_b32 v8, 0
  v_mov_b32 v9, 0
  v_mov_b32 v10, 0
  v_mov_b32 v11, 0
  v_mov_b32 v12, 0
  v_mov_b32 v13, 0
  v_mov_b32 v14, 0
  v_mov_b32 v15, 0
  v_mov_b32 v16, 0
  v_mov_b32 v17, 0
  v_mov_b32 v18, 0
  v_mov_b32 v19, 0
L_vnoflush:
  s_lshr_b32 s51, s51, 2
  s_cmp_eq_u32 s62, 7
  s_cselect_b64 vcc, -1, 0
  s_cmp_lg_u32 s62, 4
  s_cbranch_scc1 L_vloop
  s_mov_b32 s12, 0x100000
L_sp51:
  ds_read_b32 v6, v1 offset:44052
  s_waitcnt lgkmcnt(0)
  v_readfirstlane_b32 s10, v6
  s_cmp_ge_u32 s10, 8
  s_cbranch_scc1 L_sd52
  s_sleep 1
  s_sub_u32 s12, s12, 1
  s_cbranch_scc0 L_sp51
  s_branch L_end
L_sd52:
  ds_read_b32 v6, v1 offset:44064
  s_waitcnt lgkmcnt(0)
  v_mul_f32 v8, v8, v6
  v_mul_f32 v9, v9, v6
  v_mul_f32 v10, v10, v6
  v_mul_f32 v11, v11, v6
  v_mul_f32 v12, v12, v6
  v_mul_f32 v13, v13, v6
  v_mul_f32 v14, v14, v6
  v_mul_f32 v15, v15, v6
  v_mul_f32 v16, v16, v6
  v_mul_f32 v17, v17, v6
  v_mul_f32 v18, v18, v6
  v_mul_f32 v19, v19, v6
  s_branch L_vloop
L_dr1:
  v_mov_b32 v5, s50
  s_mov_b32 s12, 0x100000
L_sp53:
  ds_read_b64 v[6:7], v5 offset:44224
  s_waitcnt lgkmcnt(0)
  v_readfirstlane_b32 s10, v6
  v_readfirstlane_b32 s11, v7
  s_cmp_ge_u32 s10, 1
  s_cbranch_scc1 L_sd54
  s_sleep 1
  s_sub_u32 s12, s12, 1
  s_cbranch_scc0 L_sp53
  s_branch L_end
L_sd54:
  s_mov_b32 s73, s11
  s_branch L_cons1
L_dr12:
  s_waitcnt vmcnt(9)
  s_branch L_cons12
L_dr13:
  s_waitcnt vmcnt(6)
  s_branch L_cons13
L_dr14:
  s_waitcnt vmcnt(3)
  s_branch L_cons14
L_dr15:
  s_waitcnt vmcnt(0)
  s_branch L_cons15
L_vlast:
  s_cmp_lg_u32 s10, 3
  s_cbranch_scc1 L_nolast
L_pub:
  s_mov_b32 exec_hi, 0xffff
  ds_read_b128 v[64:67], v40 offset:16384
  ds_read_b128 v[68:71], v40 offset:17152
  ds_read_b128 v[72:75], v40 offset:17920
  ds_read_b128 v[76:79], v40 offset:18688
  ds_read_b128 v[80:83], v40 offset:19456
  ds_read_b128 v[84:87], v40 offset:20224
  ds_read_b128 v[88:91], v40 offset:20992
  ds_read_b128 v[92:95], v40 offset:21760
  s_waitcnt lgkmcnt(6)
  v_add_f32 v64, v64, v68
  v_add_f32 v65, v65, v69
  v_add_f32 v66, v66, v70
  v_add_f32 v67, v67, v71
  s_waitcnt lgkmcnt(4)
  v_add_f32 v72, v72, v76
  v_add_f32 v73, v73, v77
  v_add_f32 v74, v74, v78
  v_add_f32 v75, v75, v79
  s_waitcnt lgkmcnt(2)
  v_add_f32 v80, v80, v84
  v_add_f32 v81, v81, v85
  v_add_f32 v82, v82, v86
  v_add_f32 v83, v83, v87
  s_waitcnt lgkmcnt(0)
  v_add_f32 v88, v88, v92
  v_add_f32 v89, v89, v93
  v_add_f32 v90, v90, v94
  v_add_f32 v91, v91, v95
  v_add_f32 v64, v64, v72
  v_add_f32 v80, v80, v88
  v_add_f32 v65, v65, v73
  v_add_f32 v81, v81, v89
  v_add_f32 v66, v66, v74
  v_add_f32 v82, v82, v90
  v_add_f32 v67, v67, v75
  v_add_f32 v83, v83, v91
  v_add_f32 v64, v64, v80
  v_add_f32 v65, v65, v81
  v_add_f32 v66, v66, v82
  v_add_f32 v67, v67, v83
  v_mul_f32 v64, s73, v64
  v_mul_f32 v65, s73, v65
  v_mul_f32 v66, s73, v66
  v_mul_f32 v67, s73, v67
  v_bfi_b32 v64, 15, v44, v64
  v_bfi_b32 v65, 15, v45, v65
  v_bfi_b32 v66, 15, v46, v66
  v_bfi_b32 v67, 15, v47, v67
  buffer_store_dwordx4 v[64:67], v42, s[44:47], s13 offen sc1
  s_mov_b64 exec, -1
  s_cmp_ge_u32 s3, 4
  s_cbranch_scc1 L_pubdone
L_nolast:
  s_branch L_end
L_helper:
  s_sub_u32 s72, s3, 4
  s_sub_u32 s74, s38, 48
  s_mul_i32 s61, s74, 43
  s_lshr_b32 s61, s61, 8
  s_mul_i32 s10, s61, 6
  s_sub_u32 s73, s74, s10
  s_add_u32 s61, s61, 32
  s_cmp_lt_u32 s8, 6
  s_cselect_b32 s61, s6, s61
  s_cselect_b32 s73, s8, s73
  s_cselect_b32 s74, 0, s74
  s_cselect_b32 s70, 12, 3
  s_lshl_b32 s70, s70, 10
  s_mul_i32 s71, s70, 25
  s_cmp_ge_u32 s73, 3
  s_cselect_b32 s14, 4, 0
  s_cselect_b32 s10, 3, 0
  s_add_u32 s14, s14, s72
  s_mul_i32 s14, s14, 80
  s_sub_u32 s10, s73, s10
  s_and_b32 s11, s61, 31
  s_mul_i32 s11, s11, 3
  s_add_u32 s10, s10, s11
  s_lshl_b32 s10, s10, 7
  s_mul_i32 s13, s14, s70
  s_add_u32 s13, s13, s10
  s_lshl_b32 s14, s14, 1
  v_and_b32 v3, 15, v2
  v_lshrrev_b32 v4, 4, v2
  v_mul_u32_u24 v5, 1280, v4
  v_lshl_add_u32 v5, v3, 4, v5
  v_lshrrev_b32 v6, 2, v3
  v_mul_u32_u24 v7, 1280, v6
  v_lshl_add_u32 v38, v4, 3, v7
  v_lshl_add_u32 v7, v4, 4, v7
  v_mul_u32_u24 v45, s70, v4
  v_add_lshl_u32 v44, v45, v3, 3
  v_lshlrev_b32 v45, 2, v45
  v_lshl_add_u32 v45, v3, 3, v45
  s_or_b32 s10, s2, s72
  s_waitcnt lgkmcnt(0)
  s_cmp_lg_u32 s10, 0
  s_cbranch_scc1 L_nononce
  s_max_u32 s10, s94, 1
  v_mov_b32 v47, s10
  v_lshlrev_b32 v46, 2, v2
  global_store_dword v46, v47, s[34:35] sc1
L_nononce:
  s_mov_b32 s42, 1966080
  s_cmp_lt_u32 s8, 6
  s_cselect_b32 s40, s22, s28
  s_cselect_b32 s41, s23, s29
  s_cselect_b32 s42, 7864320, s42
  s_and_b32 s41, s41, 0xffff
  s_mov_b32 s43, 0x20000
  s_mov_b32 s48, s16
  s_and_b32 s49, s17, 0xffff
  s_mov_b32 s50, 5120
  s_mov_b32 s51, 0x20000
  s_mov_b32 s44, s36
  s_and_b32 s45, s37, 0xffff
  s_mov_b32 s46, 5242880
  s_mov_b32 s47, 0x20000
  s_setprio 2
  s_barrier
  s_barrier
  s_cmp_ge_u32 s74, 48
  s_cbranch_scc1 L_noloads
  buffer_load_dwordx4 v[8:11], v5, s[48:51], 0 offen offset:0
  buffer_load_dwordx4 v[12:15], v5, s[48:51], 0 offen offset:256
  buffer_load_dwordx4 v[16:19], v5, s[48:51], 0 offen offset:512
  buffer_load_dwordx4 v[20:23], v5, s[48:51], 0 offen offset:768
  buffer_load_dwordx4 v[24:27], v5, s[48:51], 0 offen offset:1024
  buffer_load_dwordx4 v[28:31], v7, s[48:51], s14 offen
  buffer_load_dwordx4 v[32:35], v7, s[48:51], s14 offen offset:64
  buffer_load_dwordx2 v[36:37], v38, s[48:51], s14 offen offset:128
  buffer_load_dwordx2 v[48:49], v44, s[40:43], s13 offen nt
  s_add_u32 s13, s13, s70
  buffer_load_dwordx2 v[50:51], v44, s[40:43], s13 offen nt
  s_add_u32 s13, s13, s70
  buffer_load_dwordx2 v[52:53], v44, s[40:43], s13 offen nt
  s_add_u32 s13, s13, s70
  buffer_load_dwordx2 v[54:55], v44, s[40:43], s13 offen nt
  s_add_u32 s13, s13, s70
  buffer_load_dwordx2 v[56:57], v44, s[40:43], s13 offen nt
  s_add_u32 s13, s13, s70
  buffer_load_dwordx2 v[58:59], v44, s[40:43], s13 offen nt
  s_add_u32 s13, s13, s70
  buffer_load_dwordx2 v[60:61], v44, s[40:43], s13 offen nt
  s_add_u32 s13, s13, s70
  buffer_load_dwordx2 v[62:63], v44, s[40:43], s13 offen nt
  s_add_u32 s13, s13, s71
  buffer_load_dwordx2 v[64:65], v44, s[40:43], s13 offen nt
  s_add_u32 s13, s13, s70
  buffer_load_dwordx2 v[66:67], v44, s[40:43], s13 offen nt
  s_add_u32 s13, s13, s70
  buffer_load_dwordx2 v[68:69], v44, s[40:43], s13 offen nt
  s_add_u32 s13, s13, s70
  buffer_load_dwordx2 v[70:71], v44, s[40:43], s13 offen nt
  s_add_u32 s13, s13, s70
  buffer_load_dwordx2 v[72:73], v44, s[40:43], s13 offen nt
  s_add_u32 s13, s13, s70
  buffer_load_dwordx2 v[74:75], v44, s[40:43], s13 offen nt
  s_add_u32 s13, s13, s70
  buffer_load_dwordx2 v[76:77], v44, s[40:43], s13 offen nt
  s_add_u32 s13, s13, s70
  buffer_load_dwordx2 v[78:79], v44, s[40:43], s13 offen nt
  s_add_u32 s13, s13, s71
  buffer_load_dwordx2 v[80:81], v45, s[40:43], s13 offen nt
  s_add_u32 s13, s13, s70
  buffer_load_dwordx2 v[82:83], v45, s[40:43], s13 offen nt
  s_add_u32 s13, s13, s70
  buffer_load_dwordx2 v[84:85], v45, s[40:43], s13 offen nt
  s_add_u32 s13, s13, s70
  buffer_load_dwordx2 v[86:87], v45, s[40:43], s13 offen nt
L_noloads:
  s_sub_u32 s56, s38, 32
  s_cmp_ge_u32 s56, 40
  s_cbranch_scc1 L_now2
  s_mov_b32 s52, s30
  s_and_b32 s53, s31, 0xffff
  s_mov_b32 s54, 1966080
  s_mov_b32 s55, 0x20000
  s_mul_i32 s57, s56, 52
  s_lshr_b32 s57, s57, 8
  s_mul_i32 s10, s57, 5
  s_sub_u32 s10, s56, s10
  s_lshl_b32 s10, s10, 8
  s_lshl_b32 s62, s57, 2
  s_add_u32 s62, s62, s72
  s_mul_i32 s62, s62, 61440
  s_add_u32 s62, s62, s10
  s_add_u32 s63, s62, 61440
  s_mul_i32 s10, s72, 13056
  s_add_u32 m0, s10, 45056
  s_movk_i32 s11, 1280
  v_lshlrev_b32 v232, 1, v4
  v_xor_b32 v232, v232, v3
  v_lshlrev_b32 v232, 4, v232
  v_mad_u32_u24 v232, v4, s11, v232
L_tl55:
  s_waitcnt vmcnt(39)
  buffer_load_dwordx4 v232, s[52:55], s62 offen nt lds
  s_add_u32 m0, m0, 1088
  s_add_u32 s62, s62, 5120
  s_cmp_lt_u32 s62, s63
  s_cbranch_scc1 L_tl55
L_now2:
  s_mov_b32 s64, 0xcccccccc
  s_mov_b32 s65, 0xcccccccc
  s_mov_b32 s66, 0xaaaaaaaa
  s_mov_b32 s67, 0xaaaaaaaa
  s_and_b32 s10, s2, 7
  s_lshr_b32 s77, s2, 3
  s_sub_u32 s39, s10, s4
  s_lshr_b32 s76, 0x190, s10
  s_and_b32 s76, s76, 2
  s_lshr_b32 s27, s2, 3
  s_add_u32 s0, s2, s27
  s_and_b32 s0, s0, 3
  s_lshl_b32 s27, s27, 2
  s_add_u32 s27, s27, s0
  s_mul_i32 s1, s27, 171
  s_lshr_b32 s1, s1, 9
  s_mul_i32 s94, s1, 3
  s_sub_u32 s94, s27, s94
  s_lshl_b32 s95, s94, 3
  s_or_b32 s95, s95, 0x80000
  s_bfe_u32 s0, 0x150b00, s95
  s_lshl_b32 s26, s1, 5
  s_add_u32 s0, s0, s26
  s_bfe_u32 s95, 0x0b0600, s95
  s_lshl_b32 s1, s1, 4
  s_add_u32 s1, s1, s95
  s_add_u32 s1, s1, 1365
  s_movk_i32 s95, 0x400
  s_cmp_eq_u32 s94, 1
  s_cselect_b32 s26, 10, 11
  s_cselect_b32 s95, 0x210, s95
  s_cmp_eq_u32 s27, 126
  s_cselect_b32 s1, 1360, s1
  s_cmp_eq_u32 s27, 127
  s_cselect_b32 s1, s0, s1
  s_cselect_b32 s26, 5, s26
  s_cselect_b32 s95, 16, s95
  s_bitset1_b32 s95, 15
  s_mov_b32 s68, 0x05040100
  s_mov_b32 s69, 0x07060302
  v_lshlrev_b32 v229, 4, v2
  v_and_b32 v47, 3, v2
  v_mul_u32_u24 v228, 384, v47
  v_lshl_add_u32 v228, v4, 4, v228
  v_mul_u32_u24 v233, 384, v4
  v_lshl_add_u32 v233, v6, 5, v233
  v_lshl_add_u32 v233, v47, 1, v233
  s_lshl_b32 s10, s72, 7
  v_add_u32 v233, s10, v233
  s_lshl_b32 s10, s72, 10
  v_add_u32 v230, s10, v229
  v_lshl_add_u32 v46, v6, 8, s10
  v_lshl_add_u32 v46, v4, 6, v46
  v_lshl_add_u32 v46, v47, 4, v46
  s_lshl_b32 s10, s72, 2
  v_mov_b32 v231, s10
  s_mov_b32 s60, 0
  s_cmp_ge_u32 s74, 48
  s_cbranch_scc1 L_noitem
  v_lshlrev_b32 v47, 6, v6
  s_mov_b32 s10, 0x3f803f80
  s_waitcnt vmcnt(20)
  v_dot2_f32_bf16 v40, v8, s10, 0
  v_dot2_f32_bf16 v40, v9, s10, v40
  v_dot2_f32_bf16 v40, v10, s10, v40
  v_dot2_f32_bf16 v40, v11, s10, v40
  v_dot2_f32_bf16 v40, v12, s10, v40
  v_dot2_f32_bf16 v40, v13, s10, v40
  v_dot2_f32_bf16 v40, v14, s10, v40
  v_dot2_f32_bf16 v40, v15, s10, v40
  v_dot2_f32_bf16 v40, v16, s10, v40
  v_dot2_f32_bf16 v40, v17, s10, v40
  v_dot2_f32_bf16 v40, v18, s10, v40
  v_dot2_f32_bf16 v40, v19, s10, v40
  v_dot2_f32_bf16 v40, v20, s10, v40
  v_dot2_f32_bf16 v40, v21, s10, v40
  v_dot2_f32_bf16 v40, v22, s10, v40
  v_dot2_f32_bf16 v40, v23, s10, v40
  v_dot2_f32_bf16 v40, v24, s10, v40
  v_dot2_f32_bf16 v40, v25, s10, v40
  v_dot2_f32_bf16 v40, v26, s10, v40
  v_dot2_f32_bf16 v40, v27, s10, v40
  s_nop 1
  s_nop 1
  v_add_f32_dpp v40, v40, v40 quad_perm:[1,0,3,2] row_mask:0xf bank_mask:0xf
  s_nop 1
  v_add_f32_dpp v40, v40, v40 quad_perm:[2,3,0,1] row_mask:0xf bank_mask:0xf
  s_nop 1
  v_add_f32_dpp v40, v40, v40 row_half_mirror row_mask:0xf bank_mask:0xf
  s_nop 1
  v_add_f32_dpp v40, v40, v40 row_mirror row_mask:0xf bank_mask:0xf
  v_mul_f32 v40, 0x3acccccd, v40
  v_mov_b32 v41, 0
  v_mov_b32 v42, 0
  v_lshlrev_b32 v38, 16, v8
  v_and_b32 v39, 0xffff0000, v8
  v_sub_f32 v38, v38, v40
  v_sub_f32 v39, v39, v40
  v_fmac_f32 v41, v38, v38
  v_fmac_f32 v42, v39, v39
  v_lshlrev_b32 v38, 16, v9
  v_and_b32 v39, 0xffff0000, v9
  v_sub_f32 v38, v38, v40
  v_sub_f32 v39, v39, v40
  v_fmac_f32 v41, v38, v38
  v_fmac_f32 v42, v39, v39
  v_lshlrev_b32 v38, 16, v10
  v_and_b32 v39, 0xffff0000, v10
  v_sub_f32 v38, v38, v40
  v_sub_f32 v39, v39, v40
  v_fmac_f32 v41, v38, v38
  v_fmac_f32 v42, v39, v39
  v_lshlrev_b32 v38, 16, v11
  v_and_b32 v39, 0xffff0000, v11
  v_sub_f32 v38, v38, v40
  v_sub_f32 v39, v39, v40
  v_fmac_f32 v41, v38, v38
  v_fmac_f32 v42, v39, v39
  v_lshlrev_b32 v38, 16, v12
  v_and_b32 v39, 0xffff0000, v12
  v_sub_f32 v38, v38, v40
  v_sub_f32 v39, v39, v40
  v_fmac_f32 v41, v38, v38
  v_fmac_f32 v42, v39, v39
  v_lshlrev_b32 v38, 16, v13
  v_and_b32 v39, 0xffff0000, v13
  v_sub_f32 v38, v38, v40
  v_sub_f32 v39, v39, v40
  v_fmac_f32 v41, v38, v38
  v_fmac_f32 v42, v39, v39
  v_lshlrev_b32 v38, 16, v14
  v_and_b32 v39, 0xffff0000, v14
  v_sub_f32 v38, v38, v40
  v_sub_f32 v39, v39, v40
  v_fmac_f32 v41, v38, v38
  v_fmac_f32 v42, v39, v39
  v_lshlrev_b32 v38, 16, v15
  v_and_b32 v39, 0xffff0000, v15
  v_sub_f32 v38, v38, v40
  v_sub_f32 v39, v39, v40
  v_fmac_f32 v41, v38, v38
  v_fmac_f32 v42, v39, v39
  v_lshlrev_b32 v38, 16, v16
  v_and_b32 v39, 0xffff0000, v16
  v_sub_f32 v38, v38, v40
  v_sub_f32 v39, v39, v40
  v_fmac_f32 v41, v38, v38
  v_fmac_f32 v42, v39, v39
  v_lshlrev_b32 v38, 16, v17
  v_and_b32 v39, 0xffff0000, v17
  v_sub_f32 v38, v38, v40
  v_sub_f32 v39, v39, v40
  v_fmac_f32 v41, v38, v38
  v_fmac_f32 v42, v39, v39
  v_lshlrev_b32 v38, 16, v18
  v_and_b32 v39, 0xffff0000, v18
  v_sub_f32 v38, v38, v40
  v_sub_f32 v39, v39, v40
  v_fmac_f32 v41, v38, v38
  v_fmac_f32 v42, v39, v39
  v_lshlrev_b32 v38, 16, v19
  v_and_b32 v39, 0xffff0000, v19
  v_sub_f32 v38, v38, v40
  v_sub_f32 v39, v39, v40
  v_fmac_f32 v41, v38, v38
  v_fmac_f32 v42, v39, v39
  v_lshlrev_b32 v38, 16, v20
  v_and_b32 v39, 0xffff0000, v20
  v_sub_f32 v38, v38, v40
  v_sub_f32 v39, v39, v40
  v_fmac_f32 v41, v38, v38
  v_fmac_f32 v42, v39, v39
  v_lshlrev_b32 v38, 16, v21
  v_and_b32 v39, 0xffff0000, v21
  v_sub_f32 v38, v38, v40
  v_sub_f32 v39, v39, v40
  v_fmac_f32 v41, v38, v38
  v_fmac_f32 v42, v39, v39
  v_lshlrev_b32 v38, 16, v22
  v_and_b32 v39, 0xffff0000, v22
  v_sub_f32 v38, v38, v40
  v_sub_f32 v39, v39, v40
  v_fmac_f32 v41, v38, v38
  v_fmac_f32 v42, v39, v39
  v_lshlrev_b32 v38, 16, v23
  v_and_b32 v39, 0xffff0000, v23
  v_sub_f32 v38, v38, v40
  v_sub_f32 v39, v39, v40
  v_fmac_f32 v41, v38, v38
  v_fmac_f32 v42, v39, v39
  v_lshlrev_b32 v38, 16, v24
  v_and_b32 v39, 0xffff0000, v24
  v_sub_f32 v38, v38, v40
  v_sub_f32 v39, v39, v40
  v_fmac_f32 v41, v38, v38
  v_fmac_f32 v42, v39, v39
  v_lshlrev_b32 v38, 16, v25
  v_and_b32 v39, 0xffff0000, v25
  v_sub_f32 v38, v38, v40
  v_sub_f32 v39, v39, v40
  v_fmac_f32 v41, v38, v38
  v_fmac_f32 v42, v39, v39
  v_lshlrev_b32 v38, 16, v26
  v_and_b32 v39, 0xffff0000, v26
  v_sub_f32 v38, v38, v40
  v_sub_f32 v39, v39, v40
  v_fmac_f32 v41, v38, v38
  v_fmac_f32 v42, v39, v39
  v_lshlrev_b32 v38, 16, v27
  v_and_b32 v39, 0xffff0000, v27
  v_sub_f32 v38, v38, v40
  v_sub_f32 v39, v39, v40
  v_fmac_f32 v41, v38, v38
  v_fmac_f32 v42, v39, v39
  v_add_f32 v41, v41, v42
  s_nop 1
  v_add_f32_dpp v41, v41, v41 quad_perm:[1,0,3,2] row_mask:0xf bank_mask:0xf
  s_nop 1
  v_add_f32_dpp v41, v41, v41 quad_perm:[2,3,0,1] row_mask:0xf bank_mask:0xf
  s_nop 1
  v_add_f32_dpp v41, v41, v41 row_half_mirror row_mask:0xf bank_mask:0xf
  s_nop 1
  v_add_f32_dpp v41, v41, v41 row_mirror row_mask:0xf bank_mask:0xf
  v_mul_f32 v41, 0x3acccccd, v41
  v_cvt_pk_bf16_f32 v41, v41, v41
  v_lshlrev_b32 v41, 16, v41
  v_add_f32 v41, 0x3727c5ac, v41
  v_cvt_pk_bf16_f32 v41, v41, v41
  v_lshlrev_b32 v41, 16, v41
  v_sqrt_f32 v41, v41
  s_nop 0
  v_cvt_pk_bf16_f32 v41, v41, v41
  v_lshlrev_b32 v41, 16, v41
  v_rcp_f32 v41, v41
  v_cvt_pk_bf16_f32 v40, v40, v40
  v_lshlrev_b32 v40, 16, v40
  ds_bpermute_b32 v40, v47, v40
  ds_bpermute_b32 v41, v47, v41
  v_lshlrev_b32 v8, 16, v28
  v_and_b32 v9, 0xffff0000, v28
  v_lshlrev_b32 v10, 16, v29
  v_and_b32 v11, 0xffff0000, v29
  v_lshlrev_b32 v12, 16, v30
  v_and_b32 v13, 0xffff0000, v30
  v_lshlrev_b32 v14, 16, v31
  v_and_b32 v15, 0xffff0000, v31
  v_lshlrev_b32 v16, 16, v32
  v_and_b32 v17, 0xffff0000, v32
  v_lshlrev_b32 v18, 16, v33
  v_and_b32 v19, 0xffff0000, v33
  v_lshlrev_b32 v20, 16, v34
  v_and_b32 v21, 0xffff0000, v34
  v_lshlrev_b32 v22, 16, v35
  v_and_b32 v23, 0xffff0000, v35
  v_lshlrev_b32 v24, 16, v36
  v_and_b32 v25, 0xffff0000, v36
  v_lshlrev_b32 v26, 16, v37
  v_and_b32 v27, 0xffff0000, v37
  s_waitcnt lgkmcnt(0)
  v_sub_f32 v8, v8, v40
  v_sub_f32 v9, v9, v40
  v_sub_f32 v10, v10, v40
  v_sub_f32 v11, v11, v40
  v_sub_f32 v12, v12, v40
  v_sub_f32 v13, v13, v40
  v_sub_f32 v14, v14, v40
  v_sub_f32 v15, v15, v40
  v_sub_f32 v16, v16, v40
  v_sub_f32 v17, v17, v40
  v_sub_f32 v18, v18, v40
  v_sub_f32 v19, v19, v40
  v_sub_f32 v20, v20, v40
  v_sub_f32 v21, v21, v40
  v_sub_f32 v22, v22, v40
  v_sub_f32 v23, v23, v40
  v_sub_f32 v24, v24, v40
  v_sub_f32 v25, v25, v40
  v_sub_f32 v26, v26, v40
  v_sub_f32 v27, v27, v40
  v_cvt_pk_bf16_f32 v28, v8, v9
  v_cvt_pk_bf16_f32 v29, v10, v11
  v_cvt_pk_bf16_f32 v30, v12, v13
  v_cvt_pk_bf16_f32 v31, v14, v15
  v_cvt_pk_bf16_f32 v32, v16, v17
  v_cvt_pk_bf16_f32 v33, v18, v19
  v_cvt_pk_bf16_f32 v34, v20, v21
  v_cvt_pk_bf16_f32 v35, v22, v23
  v_cvt_pk_bf16_f32 v36, v24, v25
  v_cvt_pk_bf16_f32 v37, v26, v27
  v_lshlrev_b32 v8, 16, v28
  v_and_b32 v9, 0xffff0000, v28
  v_lshlrev_b32 v10, 16, v29
  v_and_b32 v11, 0xffff0000, v29
  v_lshlrev_b32 v12, 16, v30
  v_and_b32 v13, 0xffff0000, v30
  v_lshlrev_b32 v14, 16, v31
  v_and_b32 v15, 0xffff0000, v31
  v_lshlrev_b32 v16, 16, v32
  v_and_b32 v17, 0xffff0000, v32
  v_lshlrev_b32 v18, 16, v33
  v_and_b32 v19, 0xffff0000, v33
  v_lshlrev_b32 v20, 16, v34
  v_and_b32 v21, 0xffff0000, v34
  v_lshlrev_b32 v22, 16, v35
  v_and_b32 v23, 0xffff0000, v35
  v_lshlrev_b32 v24, 16, v36
  v_and_b32 v25, 0xffff0000, v36
  v_lshlrev_b32 v26, 16, v37
  v_and_b32 v27, 0xffff0000, v37
  v_mul_f32 v8, v8, v41
  v_mul_f32 v9, v9, v41
  v_mul_f32 v10, v10, v41
  v_mul_f32 v11, v11, v41
  v_mul_f32 v12, v12, v41
  v_mul_f32 v13, v13, v41
  v_mul_f32 v14, v14, v41
  v_mul_f32 v15, v15, v41
  v_mul_f32 v16, v16, v41
  v_mul_f32 v17, v17, v41
  v_mul_f32 v18, v18, v41
  v_mul_f32 v19, v19, v41
  v_mul_f32 v20, v20, v41
  v_mul_f32 v21, v21, v41
  v_mul_f32 v22, v22, v41
  v_mul_f32 v23, v23, v41
  v_mul_f32 v24, v24, v41
  v_mul_f32 v25, v25, v41
  v_mul_f32 v26, v26, v41
  v_mul_f32 v27, v27, v41
  v_cvt_pk_bf16_f32 v144, v8, v9
  v_cvt_pk_bf16_f32 v145, v10, v11
  v_cvt_pk_bf16_f32 v146, v12, v13
  v_cvt_pk_bf16_f32 v147, v14, v15
  v_cvt_pk_bf16_f32 v148, v16, v17
  v_cvt_pk_bf16_f32 v149, v18, v19
  v_cvt_pk_bf16_f32 v150, v20, v21
  v_cvt_pk_bf16_f32 v151, v22, v23
  v_cvt_pk_bf16_f32 v152, v24, v25
  v_cvt_pk_bf16_f32 v153, v26, v27
  s_waitcnt vmcnt(12)
  v_perm_b32 v88, v50, v48, s68
  v_perm_b32 v89, v54, v52, s68
  v_perm_b32 v90, v58, v56, s68
  v_perm_b32 v91, v62, v60, s68
  v_perm_b32 v92, v50, v48, s69
  v_perm_b32 v93, v54, v52, s69
  v_perm_b32 v94, v58, v56, s69
  v_perm_b32 v95, v62, v60, s69
  v_perm_b32 v96, v51, v49, s68
  v_perm_b32 v97, v55, v53, s68
  v_perm_b32 v98, v59, v57, s68
  v_perm_b32 v99, v63, v61, s68
  v_perm_b32 v100, v51, v49, s69
  v_perm_b32 v101, v55, v53, s69
  v_perm_b32 v102, v59, v57, s69
  v_perm_b32 v103, v63, v61, s69
  s_nop 1
  v_mfma_f32_16x16x32_bf16 v[128:131], v[88:91], v[144:147], 0
  v_mfma_f32_16x16x32_bf16 v[132:135], v[92:95], v[144:147], 0
  v_mfma_f32_16x16x32_bf16 v[136:139], v[96:99], v[144:147], 0
  v_mfma_f32_16x16x32_bf16 v[140:143], v[100:103], v[144:147], 0
  s_waitcnt vmcnt(4)
  v_perm_b32 v104, v66, v64, s68
  v_perm_b32 v105, v70, v68, s68
  v_perm_b32 v106, v74, v72, s68
  v_perm_b32 v107, v78, v76, s68
  v_perm_b32 v108, v66, v64, s69
  v_perm_b32 v109, v70, v68, s69
  v_perm_b32 v110, v74, v72, s69
  v_perm_b32 v111, v78, v76, s69
  v_perm_b32 v112, v67, v65, s68
  v_perm_b32 v113, v71, v69, s68
  v_perm_b32 v114, v75, v73, s68
  v_perm_b32 v115, v79, v77, s68
  v_perm_b32 v116, v67, v65, s69
  v_perm_b32 v117, v71, v69, s69
  v_perm_b32 v118, v75, v73, s69
  v_perm_b32 v119, v79, v77, s69
  s_nop 1
  v_mfma_f32_16x16x32_bf16 v[128:131], v[104:107], v[148:151], v[128:131]
  v_mfma_f32_16x16x32_bf16 v[132:135], v[108:111], v[148:151], v[132:135]
  v_mfma_f32_16x16x32_bf16 v[136:139], v[112:115], v[148:151], v[136:139]
  v_mfma_f32_16x16x32_bf16 v[140:143], v[116:119], v[148:151], v[140:143]
  s_waitcnt vmcnt(0)
  v_perm_b32 v120, v82, v80, s68
  v_perm_b32 v121, v86, v84, s68
  v_perm_b32 v122, v82, v80, s69
  v_perm_b32 v123, v86, v84, s69
  v_perm_b32 v124, v83, v81, s68
  v_perm_b32 v125, v87, v85, s68
  v_perm_b32 v126, v83, v81, s69
  v_perm_b32 v127, v87, v85, s69
  s_nop 1
  v_mfma_f32_16x16x16_bf16 v[128:131], v[120:121], v[152:153], v[128:131]
  v_mfma_f32_16x16x16_bf16 v[132:135], v[122:123], v[152:153], v[132:135]
  v_mfma_f32_16x16x16_bf16 v[136:139], v[124:125], v[152:153], v[136:139]
  v_mfma_f32_16x16x16_bf16 v[140:143], v[126:127], v[152:153], v[140:143]
  s_nop 7
  v_cndmask_b32 v128, v128, v132, s[66:67]
  v_cndmask_b32 v136, v136, v140, s[66:67]
  v_cndmask_b32 v129, v129, v133, s[66:67]
  v_cndmask_b32 v137, v137, v141, s[66:67]
  v_cndmask_b32 v130, v130, v134, s[66:67]
  v_cndmask_b32 v138, v138, v142, s[66:67]
  v_cndmask_b32 v131, v131, v135, s[66:67]
  v_cndmask_b32 v139, v139, v143, s[66:67]
  v_cndmask_b32 v128, v128, v136, s[64:65]
  v_cndmask_b32 v129, v129, v137, s[64:65]
  v_cndmask_b32 v130, v130, v138, s[64:65]
  v_cndmask_b32 v131, v131, v139, s[64:65]
  ds_write_b128 v46, v[128:131] offset:16384
  s_mov_b64 exec, 1
  v_mov_b32 v5, 1
  ds_add_rtn_u32 v6, v1, v5 offset:44084
  s_waitcnt lgkmcnt(0)
  v_readfirstlane_b32 s10, v6
  s_mov_b64 exec, -1
  s_mov_b32 s60, s10
L_noitem:
  s_mov_b32 s12, 0x100000
L_sp56:
  ds_read_b32 v6, v1 offset:44032
  s_waitcnt lgkmcnt(0)
  v_readfirstlane_b32 s10, v6
  s_cmp_ge_u32 s10, 1
  s_cbranch_scc1 L_sd57
  s_sleep 0
  s_sub_u32 s12, s12, 1
  s_cbranch_scc0 L_sp56
  s_branch L_end
L_sd57:
  s_mov_b32 s92, s10
  s_mul_i32 s10, s92, 0x9e3779b1
  s_mul_hi_u32 s11, s92, 0x85ebca6b
  s_mul_i32 s12, s92, 0xc2b2ae35
  s_xor_b32 s11, s11, s12
  v_mov_b32 v236, s10
  v_mov_b32 v237, s11
  v_and_b32 v238, 1, v0
  v_cndmask_b32 v236, v236, v237, s[64:65]
  v_lshlrev_b32 v238, 4, v238
  v_lshrrev_b32 v236, v238, v236
  v_lshrrev_b32 v237, 4, v236
  v_lshrrev_b32 v238, 8, v236
  v_lshrrev_b32 v239, 12, v236
  s_cmp_lg_u32 s60, 3
  s_cbranch_scc1 L_nopub
  ds_read_b128 v[8:11], v229 offset:16384
  ds_read_b128 v[12:15], v229 offset:17408
  ds_read_b128 v[16:19], v229 offset:18432
  ds_read_b128 v[20:23], v229 offset:19456
  s_lshl_b32 s13, s61, 3
  s_add_u32 s13, s13, s73
  s_lshl_b32 s13, s13, 10
  s_waitcnt lgkmcnt(0)
  v_add_f32 v8, v8, v12
  v_add_f32 v16, v16, v20
  v_add_f32 v9, v9, v13
  v_add_f32 v17, v17, v21
  v_add_f32 v10, v10, v14
  v_add_f32 v18, v18, v22
  v_add_f32 v11, v11, v15
  v_add_f32 v19, v19, v23
  v_add_f32 v24, v8, v16
  v_add_f32 v25, v9, v17
  v_add_f32 v26, v10, v18
  v_add_f32 v27, v11, v19
  v_bfi_b32 v24, 15, v236, v24
  v_bfi_b32 v25, 15, v237, v25
  v_bfi_b32 v26, 15, v238, v26
  v_bfi_b32 v27, 15, v239, v27
  buffer_store_dwordx4 v[24:27], v229, s[44:47], s13 offen sc1
L_nopub:
  s_and_b32 s10, s95, 0x7fff
  s_flbit_i32_b32 s10, s10
  s_sub_u32 s11, 31, s10
  s_cmp_eq_u32 s72, 0
  s_cselect_b32 s11, 4, s11
  s_cmp_ge_u32 s72, 2
  s_cselect_b32 s11, 15, s11
  s_cmp_lt_u32 s11, s26
  s_cselect_b32 s68, s0, s1
  s_add_u32 s68, s68, s11
  s_lshr_b32 s68, s68, 4
  s_and_b32 s69, s68, 1
  s_cmp_ge_u32 s68, 86
  s_cselect_b32 s69, 2, s69
  s_cmp_eq_u32 s72, 3
  s_cbranch_scc1 L_noq
  s_and_b32 s13, s68, 31
  s_lshl_b32 s13, s13, 5
  s_lshr_b32 s10, s68, 5
  s_add_u32 s13, s13, s10
  s_lshl_b32 s13, s13, 8
  v_lshlrev_b32 v47, 10, v4
  v_lshl_add_u32 v47, v3, 4, v47
  s_lshl_b32 s10, s72, 8
  v_add_u32 v46, s10, v233
  v_lshlrev_b32 v45, 8, v4
  v_sub_u32 v46, v46, v45
  s_mov_b32 s12, 0x100000
L_sp58:
  ds_read_b32 v6, v1 offset:44144
  s_waitcnt lgkmcnt(0)
  v_readfirstlane_b32 s10, v6
  s_cmp_ge_u32 s10, 1
  s_cbranch_scc1 L_sd59
  s_sleep 2
  s_sub_u32 s12, s12, 1
  s_cbranch_scc0 L_sp58
  s_branch L_end
L_sd59:
  s_mov_b32 exec_hi, 0xffff
  s_mov_b32 s12, 0x40000
L_pl60:
  buffer_load_dwordx4 v[8:11], v47, s[44:47], s13 offen sc1
  buffer_load_dwordx4 v[12:15], v47, s[44:47], s13 offen offset:3072 sc1
  s_waitcnt vmcnt(1)
  v_xor_b32 v5, v8, v236
  v_bitop3_b32 v5, v5, v9, v237 bitop3:0xf6
  v_bitop3_b32 v5, v5, v10, v238 bitop3:0xf6
  v_bitop3_b32 v5, v5, v11, v239 bitop3:0xf6
  v_and_b32 v8, -16, v8
  v_and_b32 v9, -16, v9
  v_and_b32 v10, -16, v10
  v_and_b32 v11, -16, v11
  s_waitcnt vmcnt(0)
  v_bitop3_b32 v5, v5, v12, v236 bitop3:0xf6
  v_bitop3_b32 v5, v5, v13, v237 bitop3:0xf6
  v_bitop3_b32 v5, v5, v14, v238 bitop3:0xf6
  v_bitop3_b32 v5, v5, v15, v239 bitop3:0xf6
  v_and_b32 v12, -16, v12
  v_and_b32 v13, -16, v13
  v_and_b32 v14, -16, v14
  v_and_b32 v15, -16, v15
  v_and_b32 v5, 15, v5
  v_cmp_ne_u32 vcc, 0, v5
  s_cmp_eq_u64 vcc, 0
  s_cbranch_scc1 L_pd61
  s_sleep 8
  s_sub_u32 s12, s12, 1
  s_cbranch_scc0 L_pl60
  s_branch L_end
L_pd61:
  v_add_f32 v8, v8, v12
  v_add_f32 v9, v9, v13
  v_add_f32 v10, v10, v14
  v_add_f32 v11, v11, v15
  v_cvt_pk_bf16_f32 v8, v8, v9
  v_cvt_pk_bf16_f32 v10, v10, v11
  ds_write_b16 v46, v8 offset:42496
  ds_write_b16_d16_hi v46, v8 offset:42504
  ds_write_b16 v46, v10 offset:42512
  ds_write_b16_d16_hi v46, v10 offset:42520
  s_mov_b64 exec, 1
  v_mov_b32 v5, 1
  ds_add_u32 v1, v5 offset:44080
  s_mov_b64 exec, -1
L_noq:
  s_setprio 0
  s_mov_b32 s40, s24
  s_and_b32 s41, s25, 0xffff
  s_mov_b32 s42, 7864320
  s_mov_b32 s43, 0x20000
  s_mul_i32 s70, s77, 245760
  s_lshl_b32 s10, s39, 8
  s_add_u32 s70, s70, s10
  s_add_u32 s71, s70, 245760
  s_mov_b32 m0, 45056
  s_movk_i32 s11, 1280
  v_lshlrev_b32 v232, 1, v4
  v_xor_b32 v232, v232, v3
  v_lshlrev_b32 v232, 4, v232
  v_mad_u32_u24 v232, v4, s11, v232
  v_bfe_u32 v234, v2, 1, 1
  v_lshl_add_u32 v234, s72, 2, v234
  v_bfe_u32 v235, v2, 2, 2
  v_lshlrev_b32 v7, 1, v235
  v_xor_b32 v234, v234, v7
  v_lshlrev_b32 v234, 4, v234
  v_lshl_add_u32 v234, v235, 8, v234
  v_and_b32 v235, 1, v2
  v_lshl_add_u32 v234, v235, 3, v234
  v_xor_b32 v235, 32, v234
  v_mul_u32_u24 v7, 2176, v4
  v_add_u32 v7, 45056, v7
  v_add_u32 v234, v234, v7
  v_add_u32 v235, v235, v7
  s_mov_b32 s96, -1
  s_mov_b32 s98, 0
  s_mov_b32 s100, -1
  s_mov_b32 s101, 4294964916
  s_cmp_eq_u32 s76, 0
  s_cselect_b32 s101, 4294966676, s101
  s_sub_u32 s99, s2, 104
  s_cmp_lt_u32 s99, 16
  s_cselect_b32 s99, s99, 64
  s_cmp_lg_u32 s72, 3
  s_cbranch_scc1 L_cd63
L_cl62:
  s_add_u32 s96, s96, 1
  s_lshl_b32 s10, s96, 2
  v_mov_b32 v9, s10
  s_mov_b32 s12, 0x100000
L_sp66:
  ds_read_b32 v6, v9 offset:44288
  s_waitcnt lgkmcnt(0)
  v_readfirstlane_b32 s10, v6
  s_cmp_ge_u32 s10, 1
  s_cbranch_scc1 L_sd67
  s_sleep 4
  s_sub_u32 s12, s12, 1
  s_cbranch_scc0 L_sp66
  s_branch L_end
L_sd67:
  s_mov_b32 s97, s10
  s_mul_i32 s13, s96, 640
  s_add_u32 s13, s13, 393216
  s_cmp_ge_u32 s99, 16
  s_cbranch_scc1 L_cp64
  s_lshl_b32 s14, s99, 3
  s_add_u32 s14, s14, s13
  s_add_u32 s14, s14, 640
  v_mov_b32 v12, s92
  v_mov_b32 v13, s97
  s_mov_b64 exec, 1
  buffer_store_dwordx2 v[12:13], v1, s[44:47], s14 offen sc1
  s_mov_b64 exec, -1
L_cp64:
  s_mov_b32 s10, 0
  s_cmp_lt_u32 s96, 2
  s_cbranch_scc1 L_cp64w
  s_load_dwordx8 s[16:23], s[36:37], s13
  s_add_u32 s13, s13, 32
  s_waitcnt lgkmcnt(0)
  s_sub_u32 s11, s97, s17
  s_cmp_eq_u32 s16, s92
  s_cselect_b32 s11, s11, 0
  s_add_u32 s10, s10, s11
  s_sub_u32 s11, s97, s19
  s_cmp_eq_u32 s18, s92
  s_cselect_b32 s11, s11, 0
  s_add_u32 s10, s10, s11
  s_sub_u32 s11, s97, s21
  s_cmp_eq_u32 s20, s92
  s_cselect_b32 s11, s11, 0
  s_add_u32 s10, s10, s11
  s_sub_u32 s11, s97, s23
  s_cmp_eq_u32 s22, s92
  s_cselect_b32 s11, s11, 0
  s_add_u32 s10, s10, s11
  s_load_dwordx8 s[16:23], s[36:37], s13
  s_add_u32 s13, s13, 32
  s_waitcnt lgkmcnt(0)
  s_sub_u32 s11, s97, s17
  s_cmp_eq_u32 s16, s92
  s_cselect_b32 s11, s11, 0
  s_add_u32 s10, s10, s11
  s_sub_u32 s11, s97, s19
  s_cmp_eq_u32 s18, s92
  s_cselect_b32 s11, s11, 0
  s_add_u32 s10, s10, s11
  s_sub_u32 s11, s97, s21
  s_cmp_eq_u32 s20, s92
  s_cselect_b32 s11, s11, 0
  s_add_u32 s10, s10, s11
  s_sub_u32 s11, s97, s23
  s_cmp_eq_u32 s22, s92
  s_cselect_b32 s11, s11, 0
  s_add_u32 s10, s10, s11
  s_load_dwordx8 s[16:23], s[36:37], s13
  s_add_u32 s13, s13, 32
  s_waitcnt lgkmcnt(0)
  s_sub_u32 s11, s97, s17
  s_cmp_eq_u32 s16, s92
  s_cselect_b32 s11, s11, 0
  s_add_u32 s10, s10, s11
  s_sub_u32 s11, s97, s19
  s_cmp_eq_u32 s18, s92
  s_cselect_b32 s11, s11, 0
  s_add_u32 s10, s10, s11
  s_sub_u32 s11, s97, s21
  s_cmp_eq_u32 s20, s92
  s_cselect_b32 s11, s11, 0
  s_add_u32 s10, s10, s11
  s_sub_u32 s11, s97, s23
  s_cmp_eq_u32 s22, s92
  s_cselect_b32 s11, s11, 0
  s_add_u32 s10, s10, s11
  s_load_dwordx8 s[16:23], s[36:37], s13
  s_add_u32 s13, s13, 32
  s_waitcnt lgkmcnt(0)
  s_sub_u32 s11, s97, s17
  s_cmp_eq_u32 s16, s92
  s_cselect_b32 s11, s11, 0
  s_add_u32 s10, s10, s11
  s_sub_u32 s11, s97, s19
  s_cmp_eq_u32 s18, s92
  s_cselect_b32 s11, s11, 0
  s_add_u32 s10, s10, s11
  s_sub_u32 s11, s97, s21
  s_cmp_eq_u32 s20, s92
  s_cselect_b32 s11, s11, 0
  s_add_u32 s10, s10, s11
  s_sub_u32 s11, s97, s23
  s_cmp_eq_u32 s22, s92
  s_cselect_b32 s11, s11, 0
  s_add_u32 s10, s10, s11
L_cp64w:
  s_lshl_b32 s10, s10, 1
  s_lshl_b32 s11, s97, 5
  s_sub_u32 s11, s11, s10
  s_sub_u32 s12, s11, s98
  s_mov_b32 s98, s11
  s_cmp_le_u32 s96, 3
  s_cselect_b32 s12, 10336, s12
  s_mov_b32 s14, s100
  s_mov_b32 s100, s12
  s_cmp_lt_u32 s96, 2
  s_cbranch_scc1 L_cn65
  s_add_u32 s12, s12, s14
  s_lshr_b32 s12, s12, 3
  s_sub_u32 s10, s96, 1
  s_mul_i32 s10, s10, s12
  s_lshl_b32 s10, s10, 2
  s_sub_u32 s11, s11, s10
  s_sub_u32 s11, s11, s101
  v_mov_b32 v12, s11
  v_mov_b32 v13, s12
  ds_write_b64 v1, v[12:13] offset:44072
L_cn65:
  s_cmp_lt_u32 s96, 0
  s_cbranch_scc1 L_cl62
L_cd63:
  s_mov_b32 s12, 0x100000
L_sp68:
  ds_read_b32 v6, v1 offset:44288
  s_waitcnt lgkmcnt(0)
  v_readfirstlane_b32 s10, v6
  s_cmp_ge_u32 s10, 1
  s_cbranch_scc1 L_sd69
  s_sleep 16
  s_sub_u32 s12, s12, 1
  s_cbranch_scc0 L_sp68
  s_branch L_end
L_sd69:
  s_cmp_ge_u32 s56, 40
  s_cbranch_scc1 L_noffn
  s_lshl_b32 s75, s56, 2
  s_add_u32 s75, s75, s72
  s_lshl_b32 s75, s75, 9
  s_add_u32 s75, s75, 1638400
  s_add_u32 s13, s57, 32
  s_lshl_b32 s13, s13, 3
  s_add_u32 s13, s13, s72
  s_lshl_b32 s13, s13, 10
  s_cmp_eq_u32 s72, 3
  s_cbranch_scc1 L_fsync
  s_mov_b32 s12, 0x40000
L_pl70:
  buffer_load_dwordx4 v[8:11], v229, s[44:47], s13 offen sc1
  buffer_load_dwordx4 v[12:15], v229, s[44:47], s13 offen offset:3072 sc1
  s_waitcnt vmcnt(1)
  v_xor_b32 v5, v8, v236
  v_bitop3_b32 v5, v5, v9, v237 bitop3:0xf6
  v_bitop3_b32 v5, v5, v10, v238 bitop3:0xf6
  v_bitop3_b32 v5, v5, v11, v239 bitop3:0xf6
  v_and_b32 v8, -16, v8
  v_and_b32 v9, -16, v9
  v_and_b32 v10, -16, v10
  v_and_b32 v11, -16, v11
  s_waitcnt vmcnt(0)
  v_bitop3_b32 v5, v5, v12, v236 bitop3:0xf6
  v_bitop3_b32 v5, v5, v13, v237 bitop3:0xf6
  v_bitop3_b32 v5, v5, v14, v238 bitop3:0xf6
  v_bitop3_b32 v5, v5, v15, v239 bitop3:0xf6
  v_and_b32 v12, -16, v12
  v_and_b32 v13, -16, v13
  v_and_b32 v14, -16, v14
  v_and_b32 v15, -16, v15
  v_and_b32 v5, 15, v5
  v_cmp_ne_u32 vcc, 0, v5
  s_cmp_eq_u64 vcc, 0
  s_cbranch_scc1 L_pd71
  s_sleep 16
  s_sub_u32 s12, s12, 1
  s_cbranch_scc0 L_pl70
  s_branch L_end
L_pd71:
  v_add_f32 v8, v8, v12
  v_add_f32 v9, v9, v13
  v_add_f32 v10, v10, v14
  v_add_f32 v11, v11, v15
  v_cvt_pk_bf16_f32 v8, v8, v8
  v_lshlrev_b32 v8, 16, v8
  v_cvt_pk_bf16_f32 v9, v9, v9
  v_lshlrev_b32 v9, 16, v9
  v_cvt_pk_bf16_f32 v10, v10, v10
  v_lshlrev_b32 v10, 16, v10
  v_cvt_pk_bf16_f32 v11, v11, v11
  v_lshlrev_b32 v11, 16, v11
  v_mul_f32 v12, 0xbfb8aa3b, v8
  v_mul_f32 v13, 0xbfb8aa3b, v9
  v_mul_f32 v14, 0xbfb8aa3b, v10
  v_mul_f32 v15, 0xbfb8aa3b, v11
  v_exp_f32 v12, v12
  v_exp_f32 v13, v13
  v_exp_f32 v14, v14
  v_exp_f32 v15, v15
  v_add_f32 v12, 1.0, v12
  v_add_f32 v13, 1.0, v13
  v_add_f32 v14, 1.0, v14
  v_add_f32 v15, 1.0, v15
  v_rcp_f32 v12, v12
  v_rcp_f32 v13, v13
  v_rcp_f32 v14, v14
  v_rcp_f32 v15, v15
  v_mul_f32 v8, v8, v12
  v_mul_f32 v9, v9, v13
  v_mul_f32 v10, v10, v14
  v_mul_f32 v11, v11, v15
  v_cvt_pk_bf16_f32 v8, v8, v9
  v_cvt_pk_bf16_f32 v10, v10, v11
  ds_write_b16 v233, v8 offset:40960
  ds_write_b16_d16_hi v233, v8 offset:40968
  ds_write_b16 v233, v10 offset:40976
  ds_write_b16_d16_hi v233, v10 offset:40984
L_fsync:
  s_waitcnt vmcnt(0)
  s_mov_b64 exec, 1
  v_mov_b32 v5, 1
  ds_add_u32 v1, v5 offset:44060
  s_mov_b64 exec, -1
  s_mov_b32 s12, 0x100000
L_sp72:
  ds_read_b32 v6, v1 offset:44060
  s_waitcnt lgkmcnt(0)
  v_readfirstlane_b32 s10, v6
  s_cmp_ge_u32 s10, 4
  s_cbranch_scc1 L_sd73
  s_sleep 4
  s_sub_u32 s12, s12, 1
  s_cbranch_scc0 L_sp72
  s_branch L_end
L_sd73:
  ds_read_b64_tr_b16 v[180:181], v234 offset:0
  ds_read_b64_tr_b16 v[182:183], v234 offset:1088
  ds_read_b64_tr_b16 v[184:185], v235 offset:0
  ds_read_b64_tr_b16 v[186:187], v235 offset:1088
  ds_read_b64_tr_b16 v[188:189], v234 offset:8704
  ds_read_b64_tr_b16 v[190:191], v234 offset:9792
  ds_read_b64_tr_b16 v[192:193], v235 offset:8704
  ds_read_b64_tr_b16 v[194:195], v235 offset:9792
  ds_read_b64_tr_b16 v[196:197], v234 offset:17408
  ds_read_b64_tr_b16 v[198:199], v234 offset:18496
  ds_read_b64_tr_b16 v[200:201], v235 offset:17408
  ds_read_b64_tr_b16 v[202:203], v235 offset:18496
  ds_read_b64_tr_b16 v[204:205], v234 offset:26112
  ds_read_b64_tr_b16 v[206:207], v234 offset:27200
  ds_read_b64_tr_b16 v[208:209], v235 offset:26112
  ds_read_b64_tr_b16 v[210:211], v235 offset:27200
  ds_read_b64_tr_b16 v[212:213], v234 offset:34816
  ds_read_b64_tr_b16 v[214:215], v234 offset:35904
  ds_read_b64_tr_b16 v[216:217], v235 offset:34816
  ds_read_b64_tr_b16 v[218:219], v235 offset:35904
  ds_read_b64_tr_b16 v[220:221], v234 offset:43520
  ds_read_b64_tr_b16 v[222:223], v234 offset:44608
  ds_read_b64_tr_b16 v[224:225], v235 offset:43520
  ds_read_b64_tr_b16 v[226:227], v235 offset:44608
  s_waitcnt lgkmcnt(0)
  ds_read_b128 v[8:11], v228 offset:40960
  ds_read_b128 v[12:15], v228 offset:41024
  ds_read_b128 v[16:19], v228 offset:41088
  ds_read_b128 v[20:23], v228 offset:41152
  ds_read_b128 v[24:27], v228 offset:41216
  ds_read_b128 v[28:31], v228 offset:41280
  s_waitcnt lgkmcnt(5)
  v_mfma_f32_16x16x32_bf16 v[32:35], v[8:11], v[180:183], 0
  v_mfma_f32_16x16x32_bf16 v[36:39], v[8:11], v[184:187], 0
  s_waitcnt lgkmcnt(4)
  v_mfma_f32_16x16x32_bf16 v[32:35], v[12:15], v[188:191], v[32:35]
  v_mfma_f32_16x16x32_bf16 v[36:39], v[12:15], v[192:195], v[36:39]
  s_waitcnt lgkmcnt(3)
  v_mfma_f32_16x16x32_bf16 v[32:35], v[16:19], v[196:199], v[32:35]
  v_mfma_f32_16x16x32_bf16 v[36:39], v[16:19], v[200:203], v[36:39]
  s_waitcnt lgkmcnt(2)
  v_mfma_f32_16x16x32_bf16 v[32:35], v[20:23], v[204:207], v[32:35]
  v_mfma_f32_16x16x32_bf16 v[36:39], v[20:23], v[208:211], v[36:39]
  s_waitcnt lgkmcnt(1)
  v_mfma_f32_16x16x32_bf16 v[32:35], v[24:27], v[212:215], v[32:35]
  v_mfma_f32_16x16x32_bf16 v[36:39], v[24:27], v[216:219], v[36:39]
  s_waitcnt lgkmcnt(0)
  v_mfma_f32_16x16x32_bf16 v[32:35], v[28:31], v[220:223], v[32:35]
  v_mfma_f32_16x16x32_bf16 v[36:39], v[28:31], v[224:227], v[36:39]
  s_mov_b32 vcc_lo, 0xffff0000
  s_mov_b32 vcc_hi, 0
  s_nop 6
  v_cndmask_b32 v32, v32, v36, vcc
  v_cndmask_b32 v33, v33, v37, vcc
  v_cndmask_b32 v34, v34, v38, vcc
  v_cndmask_b32 v35, v35, v39, vcc
  v_bfi_b32 v32, 15, v236, v32
  v_bfi_b32 v33, 15, v237, v33
  v_bfi_b32 v34, 15, v238, v34
  v_bfi_b32 v35, 15, v239, v35
  s_mov_b32 exec_hi, 0
  buffer_store_dwordx4 v[32:35], v229, s[44:47], s75 offen sc1
  s_mov_b64 exec, -1
L_noffn:
  s_cmp_lg_u32 s76, 0
  s_cbranch_scc1 L_noproj
  s_lshl_b32 s10, s39, 2
  s_add_u32 s10, s10, s72
  s_lshl_b32 s10, s10, 9
  s_mul_i32 s75, s77, 10240
  s_add_u32 s75, s75, s10
  s_add_u32 s75, s75, 1310720
  s_and_b32 s13, s2, 7
  s_lshl_b32 s13, s13, 3
  s_add_u32 s13, s13, 1802240
  v_lshlrev_b32 v9, 6, v2
  s_mov_b32 exec_hi, 0
  buffer_load_dwordx2 v[10:11], v9, s[44:47], s13 offen sc1
  s_waitcnt vmcnt(0)
  v_lshrrev_b32 v11, 1, v11
  v_xor_b32 v10, s92, v10
  v_bitop3_b32 v10, v10, v11, s7 bitop3:0xf6
  v_cmp_ne_u32 vcc, 0, v10
  s_mov_b32 exec_hi, -1
  s_cmp_eq_u64 vcc, 0
  s_cselect_b32 s58, 1, 0
L_noproj:
  s_mov_b32 s12, 0x100000
L_sp74:
  ds_read_b64 v[6:7], v1 offset:44040
  s_waitcnt lgkmcnt(0)
  v_readfirstlane_b32 s10, v6
  v_readfirstlane_b32 s11, v7
  s_cmp_ge_u32 s10, 1
  s_cbranch_scc1 L_sd75
  s_sleep 4
  s_sub_u32 s12, s12, 1
  s_cbranch_scc0 L_sp74
  s_branch L_end
L_sd75:
  s_mov_b32 s59, s11
  s_cmp_lg_u32 s72, 3
  s_cbranch_scc1 L_cd80
L_cl79:
  s_add_u32 s96, s96, 1
  s_lshl_b32 s10, s96, 2
  v_mov_b32 v9, s10
  s_mov_b32 s12, 0x100000
L_sp83:
  ds_read_b32 v6, v9 offset:44288
  s_waitcnt lgkmcnt(0)
  v_readfirstlane_b32 s10, v6
  s_cmp_ge_u32 s10, 1
  s_cbranch_scc1 L_sd84
  s_sleep 4
  s_sub_u32 s12, s12, 1
  s_cbranch_scc0 L_sp83
  s_branch L_end
L_sd84:
  s_mov_b32 s97, s10
  s_mul_i32 s13, s96, 640
  s_add_u32 s13, s13, 393216
  s_cmp_ge_u32 s99, 16
  s_cbranch_scc1 L_cp81
  s_lshl_b32 s14, s99, 3
  s_add_u32 s14, s14, s13
  s_add_u32 s14, s14, 640
  v_mov_b32 v12, s92
  v_mov_b32 v13, s97
  s_mov_b64 exec, 1
  buffer_store_dwordx2 v[12:13], v1, s[44:47], s14 offen sc1
  s_mov_b64 exec, -1
L_cp81:
  s_mov_b32 s10, 0
  s_cmp_lt_u32 s96, 2
  s_cbranch_scc1 L_cp81w
  s_load_dwordx8 s[16:23], s[36:37], s13
  s_add_u32 s13, s13, 32
  s_waitcnt lgkmcnt(0)
  s_sub_u32 s11, s97, s17
  s_cmp_eq_u32 s16, s92
  s_cselect_b32 s11, s11, 0
  s_add_u32 s10, s10, s11
  s_sub_u32 s11, s97, s19
  s_cmp_eq_u32 s18, s92
  s_cselect_b32 s11, s11, 0
  s_add_u32 s10, s10, s11
  s_sub_u32 s11, s97, s21
  s_cmp_eq_u32 s20, s92
  s_cselect_b32 s11, s11, 0
  s_add_u32 s10, s10, s11
  s_sub_u32 s11, s97, s23
  s_cmp_eq_u32 s22, s92
  s_cselect_b32 s11, s11, 0
  s_add_u32 s10, s10, s11
  s_load_dwordx8 s[16:23], s[36:37], s13
  s_add_u32 s13, s13, 32
  s_waitcnt lgkmcnt(0)
  s_sub_u32 s11, s97, s17
  s_cmp_eq_u32 s16, s92
  s_cselect_b32 s11, s11, 0
  s_add_u32 s10, s10, s11
  s_sub_u32 s11, s97, s19
  s_cmp_eq_u32 s18, s92
  s_cselect_b32 s11, s11, 0
  s_add_u32 s10, s10, s11
  s_sub_u32 s11, s97, s21
  s_cmp_eq_u32 s20, s92
  s_cselect_b32 s11, s11, 0
  s_add_u32 s10, s10, s11
  s_sub_u32 s11, s97, s23
  s_cmp_eq_u32 s22, s92
  s_cselect_b32 s11, s11, 0
  s_add_u32 s10, s10, s11
  s_load_dwordx8 s[16:23], s[36:37], s13
  s_add_u32 s13, s13, 32
  s_waitcnt lgkmcnt(0)
  s_sub_u32 s11, s97, s17
  s_cmp_eq_u32 s16, s92
  s_cselect_b32 s11, s11, 0
  s_add_u32 s10, s10, s11
  s_sub_u32 s11, s97, s19
  s_cmp_eq_u32 s18, s92
  s_cselect_b32 s11, s11, 0
  s_add_u32 s10, s10, s11
  s_sub_u32 s11, s97, s21
  s_cmp_eq_u32 s20, s92
  s_cselect_b32 s11, s11, 0
  s_add_u32 s10, s10, s11
  s_sub_u32 s11, s97, s23
  s_cmp_eq_u32 s22, s92
  s_cselect_b32 s11, s11, 0
  s_add_u32 s10, s10, s11
  s_load_dwordx8 s[16:23], s[36:37], s13
  s_add_u32 s13, s13, 32
  s_waitcnt lgkmcnt(0)
  s_sub_u32 s11, s97, s17
  s_cmp_eq_u32 s16, s92
  s_cselect_b32 s11, s11, 0
  s_add_u32 s10, s10, s11
  s_sub_u32 s11, s97, s19
  s_cmp_eq_u32 s18, s92
  s_cselect_b32 s11, s11, 0
  s_add_u32 s10, s10, s11
  s_sub_u32 s11, s97, s21
  s_cmp_eq_u32 s20, s92
  s_cselect_b32 s11, s11, 0
  s_add_u32 s10, s10, s11
  s_sub_u32 s11, s97, s23
  s_cmp_eq_u32 s22, s92
  s_cselect_b32 s11, s11, 0
  s_add_u32 s10, s10, s11
L_cp81w:
  s_lshl_b32 s10, s10, 1
  s_lshl_b32 s11, s97, 5
  s_sub_u32 s11, s11, s10
  s_sub_u32 s12, s11, s98
  s_mov_b32 s98, s11
  s_cmp_le_u32 s96, 3
  s_cselect_b32 s12, 10336, s12
  s_mov_b32 s14, s100
  s_mov_b32 s100, s12
  s_cmp_lt_u32 s96, 2
  s_cbranch_scc1 L_cn82
  s_add_u32 s12, s12, s14
  s_lshr_b32 s12, s12, 3
  s_sub_u32 s10, s96, 1
  s_mul_i32 s10, s10, s12
  s_lshl_b32 s10, s10, 2
  s_sub_u32 s11, s11, s10
  s_sub_u32 s11, s11, s101
  v_mov_b32 v12, s11
  v_mov_b32 v13, s12
  ds_write_b64 v1, v[12:13] offset:44072
L_cn82:
  s_cmp_lt_u32 s96, 8
  s_cbranch_scc1 L_cl79
L_cd80:
  s_mov_b32 s12, 0x100000
L_sp85:
  ds_read_b32 v6, v1 offset:44112
  s_waitcnt lgkmcnt(0)
  v_readfirstlane_b32 s10, v6
  s_cmp_ge_u32 s10, 4
  s_cbranch_scc1 L_sd86
  s_sleep 8
  s_sub_u32 s12, s12, 1
  s_cbranch_scc0 L_sp85
  s_branch L_end
L_sd86:
  ds_read_b128 v[32:35], v230 offset:0
  s_lshr_b32 s62, s59, 16
  s_xor_b32 s62, s62, s59
  s_lshl_b32 s11, s72, 1
  s_add_u32 s11, s11, 0
  s_lshr_b32 s10, s62, s11
  s_bitcmp1_b32 s10, 0
  s_cselect_b32 s52, -1, 0
  s_bitcmp1_b32 s10, 1
  s_cselect_b32 s53, -1, 0
  s_lshr_b32 s10, s59, 16
  s_xor_b32 s10, s10, s4
  s_bitcmp1_b32 s10, 0
  s_cselect_b32 s54, -1, 0
  s_xor_b32 s54, s54, 0xffff0000
  s_cmp_eq_u32 s72, 0
  s_cselect_b32 s54, s54, s52
  s_mov_b32 s55, s53
  s_or_b64 s[60:61], s[52:53], s[54:55]
  s_lshl_b32 s13, s2, 12
  s_add_u32 s13, s13, 2097152
  s_xor_b32 s14, s13, 16384
  v_mov_b32 v30, v230
  s_lshl_b32 s15, s2, 3
  s_add_u32 s15, s15, 1966080
  s_waitcnt lgkmcnt(0)
  s_cmp_eq_u64 s[60:61], 0
  s_cbranch_scc1 L_fk78s
  s_mov_b64 exec, s[60:61]
  buffer_store_dwordx4 v[32:35], v30, s[44:47], s13 offen sc1 nt
  s_waitcnt vmcnt(0)
L_fk78s:
  s_mov_b64 exec, 1
  v_mov_b32 v5, 1
  ds_add_rtn_u32 v6, v1, v5 offset:44088
  s_waitcnt lgkmcnt(0)
  v_readfirstlane_b32 s10, v6
  s_mov_b64 exec, -1
  s_cmp_lg_u32 s10, 3
  s_cbranch_scc1 L_fk78f
  s_bfe_u32 s10, s62, 524288
  v_mov_b32 v5, s92
  v_lshlrev_b32 v6, 2, v2
  s_mov_b32 exec_lo, 0x3
  s_mov_b32 exec_hi, 0
  buffer_store_dword v5, v6, s[44:47], s15 offen sc1
  s_mov_b64 exec, -1
L_fk78f:
  s_xor_b32 s56, s15, 32
  s_mov_b32 s57, s14
  s_cmp_lg_u32 s72, 3
  s_cbranch_scc1 L_cd88
L_cl87:
  s_add_u32 s96, s96, 1
  s_lshl_b32 s10, s96, 2
  v_mov_b32 v9, s10
  s_mov_b32 s12, 0x100000
L_sp91:
  ds_read_b32 v6, v9 offset:44288
  s_waitcnt lgkmcnt(0)
  v_readfirstlane_b32 s10, v6
  s_cmp_ge_u32 s10, 1
  s_cbranch_scc1 L_sd92
  s_sleep 4
  s_sub_u32 s12, s12, 1
  s_cbranch_scc0 L_sp91
  s_branch L_end
L_sd92:
  s_mov_b32 s97, s10
  s_mul_i32 s13, s96, 640
  s_add_u32 s13, s13, 393216
  s_cmp_ge_u32 s99, 16
  s_cbranch_scc1 L_cp89
  s_lshl_b32 s14, s99, 3
  s_add_u32 s14, s14, s13
  s_add_u32 s14, s14, 640
  v_mov_b32 v12, s92
  v_mov_b32 v13, s97
  s_mov_b64 exec, 1
  buffer_store_dwordx2 v[12:13], v1, s[44:47], s14 offen sc1
  s_mov_b64 exec, -1
L_cp89:
  s_mov_b32 s10, 0
  s_cmp_lt_u32 s96, 2
  s_cbranch_scc1 L_cp89w
  s_load_dwordx8 s[16:23], s[36:37], s13
  s_add_u32 s13, s13, 32
  s_waitcnt lgkmcnt(0)
  s_sub_u32 s11, s97, s17
  s_cmp_eq_u32 s16, s92
  s_cselect_b32 s11, s11, 0
  s_add_u32 s10, s10, s11
  s_sub_u32 s11, s97, s19
  s_cmp_eq_u32 s18, s92
  s_cselect_b32 s11, s11, 0
  s_add_u32 s10, s10, s11
  s_sub_u32 s11, s97, s21
  s_cmp_eq_u32 s20, s92
  s_cselect_b32 s11, s11, 0
  s_add_u32 s10, s10, s11
  s_sub_u32 s11, s97, s23
  s_cmp_eq_u32 s22, s92
  s_cselect_b32 s11, s11, 0
  s_add_u32 s10, s10, s11
  s_load_dwordx8 s[16:23], s[36:37], s13
  s_add_u32 s13, s13, 32
  s_waitcnt lgkmcnt(0)
  s_sub_u32 s11, s97, s17
  s_cmp_eq_u32 s16, s92
  s_cselect_b32 s11, s11, 0
  s_add_u32 s10, s10, s11
  s_sub_u32 s11, s97, s19
  s_cmp_eq_u32 s18, s92
  s_cselect_b32 s11, s11, 0
  s_add_u32 s10, s10, s11
  s_sub_u32 s11, s97, s21
  s_cmp_eq_u32 s20, s92
  s_cselect_b32 s11, s11, 0
  s_add_u32 s10, s10, s11
  s_sub_u32 s11, s97, s23
  s_cmp_eq_u32 s22, s92
  s_cselect_b32 s11, s11, 0
  s_add_u32 s10, s10, s11
  s_load_dwordx8 s[16:23], s[36:37], s13
  s_add_u32 s13, s13, 32
  s_waitcnt lgkmcnt(0)
  s_sub_u32 s11, s97, s17
  s_cmp_eq_u32 s16, s92
  s_cselect_b32 s11, s11, 0
  s_add_u32 s10, s10, s11
  s_sub_u32 s11, s97, s19
  s_cmp_eq_u32 s18, s92
  s_cselect_b32 s11, s11, 0
  s_add_u32 s10, s10, s11
  s_sub_u32 s11, s97, s21
  s_cmp_eq_u32 s20, s92
  s_cselect_b32 s11, s11, 0
  s_add_u32 s10, s10, s11
  s_sub_u32 s11, s97, s23
  s_cmp_eq_u32 s22, s92
  s_cselect_b32 s11, s11, 0
  s_add_u32 s10, s10, s11
  s_load_dwordx8 s[16:23], s[36:37], s13
  s_add_u32 s13, s13, 32
  s_waitcnt lgkmcnt(0)
  s_sub_u32 s11, s97, s17
  s_cmp_eq_u32 s16, s92
  s_cselect_b32 s11, s11, 0
  s_add_u32 s10, s10, s11
  s_sub_u32 s11, s97, s19
  s_cmp_eq_u32 s18, s92
  s_cselect_b32 s11, s11, 0
  s_add_u32 s10, s10, s11
  s_sub_u32 s11, s97, s21
  s_cmp_eq_u32 s20, s92
  s_cselect_b32 s11, s11, 0
  s_add_u32 s10, s10, s11
  s_sub_u32 s11, s97, s23
  s_cmp_eq_u32 s22, s92
  s_cselect_b32 s11, s11, 0
  s_add_u32 s10, s10, s11
L_cp89w:
  s_lshl_b32 s10, s10, 1
  s_lshl_b32 s11, s97, 5
  s_sub_u32 s11, s11, s10
  s_sub_u32 s12, s11, s98
  s_mov_b32 s98, s11
  s_cmp_le_u32 s96, 3
  s_cselect_b32 s12, 10336, s12
  s_mov_b32 s14, s100
  s_mov_b32 s100, s12
  s_cmp_lt_u32 s96, 2
  s_cbranch_scc1 L_cn90
  s_add_u32 s12, s12, s14
  s_lshr_b32 s12, s12, 3
  s_sub_u32 s10, s96, 1
  s_mul_i32 s10, s10, s12
  s_lshl_b32 s10, s10, 2
  s_sub_u32 s11, s11, s10
  s_sub_u32 s11, s11, s101
  v_mov_b32 v12, s11
  v_mov_b32 v13, s12
  ds_write_b64 v1, v[12:13] offset:44072
L_cn90:
  s_cmp_lt_u32 s96, 10
  s_cbranch_scc1 L_cl87
L_cd88:
  s_cmp_eq_u64 s[60:61], 0
  s_cbranch_scc1 L_fk78
  s_mov_b32 s12, 0x100000
L_sp93:
  ds_read_b32 v6, v1 offset:44328
  s_waitcnt lgkmcnt(0)
  v_readfirstlane_b32 s10, v6
  s_cmp_ge_u32 s10, 1
  s_cbranch_scc1 L_sd94
  s_sleep 16
  s_sub_u32 s12, s12, 1
  s_cbranch_scc0 L_sp93
  s_branch L_end
L_sd94:
  s_load_dword s10, s[36:37], s56
  s_waitcnt lgkmcnt(0)
  s_cmp_eq_u32 s10, s92
  s_cbranch_scc1 L_fd77
  s_mov_b32 s12, 0x40000
  s_mov_b64 exec, 1
L_fl76:
  buffer_load_dword v6, v1, s[44:47], s56 offen sc1
  s_waitcnt vmcnt(0)
  v_readfirstlane_b32 s10, v6
  s_cmp_eq_u32 s10, s92
  s_cbranch_scc1 L_fd77
  s_sleep 24
  s_sub_u32 s12, s12, 1
  s_cbranch_scc0 L_fl76
  s_branch L_end
L_fd77:
  s_mov_b64 exec, s[60:61]
  buffer_load_dwordx4 v[36:39], v30, s[44:47], s57 offen sc1 nt
  s_mov_b64 exec, -1
  s_waitcnt vmcnt(0)
  v_cndmask_b32 v32, v32, v36, s[54:55]
  v_cndmask_b32 v33, v33, v37, s[54:55]
  v_cndmask_b32 v34, v34, v38, s[54:55]
  v_cndmask_b32 v35, v35, v39, s[54:55]
L_fk78:
  v_lshlrev_b32 v8, 16, v32
  v_and_b32 v9, 0xffff0000, v32
  v_lshlrev_b32 v10, 16, v33
  v_and_b32 v11, 0xffff0000, v33
  v_lshlrev_b32 v12, 16, v34
  v_and_b32 v13, 0xffff0000, v34
  v_lshlrev_b32 v14, 16, v35
  v_and_b32 v15, 0xffff0000, v35
  v_max3_f32 v24, v8, v9, v10
  v_max3_f32 v24, v24, v11, v12
  v_max3_f32 v24, v24, v13, v14
  v_max_f32 v24, v24, v15
  s_nop 1
  v_max_f32_dpp v24, v24, v24 quad_perm:[1,0,3,2] row_mask:0xf bank_mask:0xf
  s_nop 1
  v_max_f32_dpp v24, v24, v24 quad_perm:[2,3,0,1] row_mask:0xf bank_mask:0xf
  s_nop 1
  v_max_f32_dpp v24, v24, v24 row_half_mirror row_mask:0xf bank_mask:0xf
  s_nop 1
  v_max_f32_dpp v24, v24, v24 row_mirror row_mask:0xf bank_mask:0xf
  v_mov_b32 v25, v24
  s_nop 1
  v_permlane16_swap_b32 v24, v25
  s_nop 1
  v_max_f32 v24, v24, v25
  v_lshrrev_b32 v27, 5, v2
  v_lshl_add_u32 v27, s72, 1, v27
  v_add_u32 v27, 0, v27
  v_cmp_gt_u32 vcc, s26, v27
  v_add_u32 v26, s1, v27
  v_add_u32 v7, s0, v27
  v_cndmask_b32 v26, v26, v7, vcc
  v_cmp_le_u32 vcc, 1376, v26
  v_bfe_u32 v26, v26, 4, 1
  s_nop 0
  v_cndmask_b32 v26, v26, 2, vcc
  v_lshlrev_b32 v26, 5, v26
  v_lshlrev_b32 v27, 2, v27
  s_mov_b32 exec_lo, 1
  s_mov_b32 exec_hi, 1
  ds_max_f32 v26, v24 offset:44416
  s_mov_b64 exec, 1
  v_mov_b32 v5, 1
  ds_add_u32 v1, v5 offset:44056
  s_mov_b64 exec, -1
  s_mov_b32 s12, 0x100000
L_sp95:
  ds_read_b32 v6, v1 offset:44056
  s_waitcnt lgkmcnt(0)
  v_readfirstlane_b32 s10, v6
  s_cmp_ge_u32 s10, 4
  s_cbranch_scc1 L_sd96
  s_sleep 2
  s_sub_u32 s12, s12, 1
  s_cbranch_scc0 L_sp95
  s_branch L_end
L_sd96:
  ds_read_b32 v24, v26 offset:44416
  s_mov_b32 s10, 0x3fb8aa3b
  s_waitcnt lgkmcnt(0)
  v_sub_f32 v8, v8, v24
  v_sub_f32 v9, v9, v24
  v_sub_f32 v10, v10, v24
  v_sub_f32 v11, v11, v24
  v_sub_f32 v12, v12, v24
  v_sub_f32 v13, v13, v24
  v_sub_f32 v14, v14, v24
  v_sub_f32 v15, v15, v24
  v_mul_f32 v8, s10, v8
  v_mul_f32 v9, s10, v9
  v_mul_f32 v10, s10, v10
  v_mul_f32 v11, s10, v11
  v_mul_f32 v12, s10, v12
  v_mul_f32 v13, s10, v13
  v_mul_f32 v14, s10, v14
  v_mul_f32 v15, s10, v15
  v_exp_f32 v8, v8
  v_exp_f32 v9, v9
  v_exp_f32 v10, v10
  v_exp_f32 v11, v11
  v_exp_f32 v12, v12
  v_exp_f32 v13, v13
  v_exp_f32 v14, v14
  v_exp_f32 v15, v15
  v_cvt_pk_bf16_f32 v32, v8, v9
  v_cvt_pk_bf16_f32 v33, v10, v11
  v_cvt_pk_bf16_f32 v34, v12, v13
  v_cvt_pk_bf16_f32 v35, v14, v15
  ds_write_b128 v230, v[32:35] offset:8192
  s_mov_b64 exec, 1
  v_mov_b32 v5, 1
  ds_add_u32 v1, v5 offset:44052
  s_mov_b64 exec, -1
  v_add_f32 v8, v8, v12
  v_add_f32 v9, v9, v13
  v_add_f32 v10, v10, v14
  v_add_f32 v11, v11, v15
  v_add_f32 v8, v8, v10
  v_add_f32 v9, v9, v11
  v_add_f32 v8, v8, v9
  s_nop 1
  v_add_f32_dpp v8, v8, v8 quad_perm:[1,0,3,2] row_mask:0xf bank_mask:0xf
  s_nop 1
  v_add_f32_dpp v8, v8, v8 quad_perm:[2,3,0,1] row_mask:0xf bank_mask:0xf
  s_nop 1
  v_add_f32_dpp v8, v8, v8 row_half_mirror row_mask:0xf bank_mask:0xf
  s_nop 1
  v_add_f32_dpp v8, v8, v8 row_mirror row_mask:0xf bank_mask:0xf
  v_mov_b32 v9, v8
  s_nop 1
  v_permlane16_swap_b32 v8, v9
  s_nop 1
  v_add_f32 v8, v8, v9
  ds_write_b32 v27, v8 offset:44160
  s_cmp_lg_u32 s72, 3
  s_cbranch_scc1 L_cd101
L_cl100:
  s_add_u32 s96, s96, 1
  s_lshl_b32 s10, s96, 2
  v_mov_b32 v9, s10
  s_mov_b32 s12, 0x100000
L_sp104:
  ds_read_b32 v6, v9 offset:44288
  s_waitcnt lgkmcnt(0)
  v_readfirstlane_b32 s10, v6
  s_cmp_ge_u32 s10, 1
  s_cbranch_scc1 L_sd105
  s_sleep 4
  s_sub_u32 s12, s12, 1
  s_cbranch_scc0 L_sp104
  s_branch L_end
L_sd105:
  s_mov_b32 s97, s10
  s_mul_i32 s13, s96, 640
  s_add_u32 s13, s13, 393216
  s_cmp_ge_u32 s99, 16
  s_cbranch_scc1 L_cp102
  s_lshl_b32 s14, s99, 3
  s_add_u32 s14, s14, s13
  s_add_u32 s14, s14, 640
  v_mov_b32 v12, s92
  v_mov_b32 v13, s97
  s_mov_b64 exec, 1
  buffer_store_dwordx2 v[12:13], v1, s[44:47], s14 offen sc1
  s_mov_b64 exec, -1
L_cp102:
  s_mov_b32 s10, 0
  s_cmp_lt_u32 s96, 2
  s_cbranch_scc1 L_cp102w
  s_load_dwordx8 s[16:23], s[36:37], s13
  s_add_u32 s13, s13, 32
  s_waitcnt lgkmcnt(0)
  s_sub_u32 s11, s97, s17
  s_cmp_eq_u32 s16, s92
  s_cselect_b32 s11, s11, 0
  s_add_u32 s10, s10, s11
  s_sub_u32 s11, s97, s19
  s_cmp_eq_u32 s18, s92
  s_cselect_b32 s11, s11, 0
  s_add_u32 s10, s10, s11
  s_sub_u32 s11, s97, s21
  s_cmp_eq_u32 s20, s92
  s_cselect_b32 s11, s11, 0
  s_add_u32 s10, s10, s11
  s_sub_u32 s11, s97, s23
  s_cmp_eq_u32 s22, s92
  s_cselect_b32 s11, s11, 0
  s_add_u32 s10, s10, s11
  s_load_dwordx8 s[16:23], s[36:37], s13
  s_add_u32 s13, s13, 32
  s_waitcnt lgkmcnt(0)
  s_sub_u32 s11, s97, s17
  s_cmp_eq_u32 s16, s92
  s_cselect_b32 s11, s11, 0
  s_add_u32 s10, s10, s11
  s_sub_u32 s11, s97, s19
  s_cmp_eq_u32 s18, s92
  s_cselect_b32 s11, s11, 0
  s_add_u32 s10, s10, s11
  s_sub_u32 s11, s97, s21
  s_cmp_eq_u32 s20, s92
  s_cselect_b32 s11, s11, 0
  s_add_u32 s10, s10, s11
  s_sub_u32 s11, s97, s23
  s_cmp_eq_u32 s22, s92
  s_cselect_b32 s11, s11, 0
  s_add_u32 s10, s10, s11
  s_load_dwordx8 s[16:23], s[36:37], s13
  s_add_u32 s13, s13, 32
  s_waitcnt lgkmcnt(0)
  s_sub_u32 s11, s97, s17
  s_cmp_eq_u32 s16, s92
  s_cselect_b32 s11, s11, 0
  s_add_u32 s10, s10, s11
  s_sub_u32 s11, s97, s19
  s_cmp_eq_u32 s18, s92
  s_cselect_b32 s11, s11, 0
  s_add_u32 s10, s10, s11
  s_sub_u32 s11, s97, s21
  s_cmp_eq_u32 s20, s92
  s_cselect_b32 s11, s11, 0
  s_add_u32 s10, s10, s11
  s_sub_u32 s11, s97, s23
  s_cmp_eq_u32 s22, s92
  s_cselect_b32 s11, s11, 0
  s_add_u32 s10, s10, s11
  s_load_dwordx8 s[16:23], s[36:37], s13
  s_add_u32 s13, s13, 32
  s_waitcnt lgkmcnt(0)
  s_sub_u32 s11, s97, s17
  s_cmp_eq_u32 s16, s92
  s_cselect_b32 s11, s11, 0
  s_add_u32 s10, s10, s11
  s_sub_u32 s11, s97, s19
  s_cmp_eq_u32 s18, s92
  s_cselect_b32 s11, s11, 0
  s_add_u32 s10, s10, s11
  s_sub_u32 s11, s97, s21
  s_cmp_eq_u32 s20, s92
  s_cselect_b32 s11, s11, 0
  s_add_u32 s10, s10, s11
  s_sub_u32 s11, s97, s23
  s_cmp_eq_u32 s22, s92
  s_cselect_b32 s11, s11, 0
  s_add_u32 s10, s10, s11
L_cp102w:
  s_lshl_b32 s10, s10, 1
  s_lshl_b32 s11, s97, 5
  s_sub_u32 s11, s11, s10
  s_sub_u32 s12, s11, s98
  s_mov_b32 s98, s11
  s_cmp_le_u32 s96, 3
  s_cselect_b32 s12, 10336, s12
  s_mov_b32 s14, s100
  s_mov_b32 s100, s12
  s_cmp_lt_u32 s96, 2
  s_cbranch_scc1 L_cn103
  s_add_u32 s12, s12, s14
  s_lshr_b32 s12, s12, 3
  s_sub_u32 s10, s96, 1
  s_mul_i32 s10, s10, s12
  s_lshl_b32 s10, s10, 2
  s_sub_u32 s11, s11, s10
  s_sub_u32 s11, s11, s101
  v_mov_b32 v12, s11
  v_mov_b32 v13, s12
  ds_write_b64 v1, v[12:13] offset:44072
L_cn103:
  s_cmp_lt_u32 s96, 16
  s_cbranch_scc1 L_cl100
L_cd101:
  s_mov_b32 s12, 0x100000
L_sp106:
  ds_read_b32 v6, v1 offset:44116
  s_waitcnt lgkmcnt(0)
  v_readfirstlane_b32 s10, v6
  s_cmp_ge_u32 s10, 4
  s_cbranch_scc1 L_sd107
  s_sleep 8
  s_sub_u32 s12, s12, 1
  s_cbranch_scc0 L_sp106
  s_branch L_end
L_sd107:
  ds_read_b128 v[32:35], v230 offset:4096
  s_lshr_b32 s62, s59, 16
  s_xor_b32 s62, s62, s59
  s_lshl_b32 s11, s72, 1
  s_add_u32 s11, s11, 8
  s_lshr_b32 s10, s62, s11
  s_bitcmp1_b32 s10, 0
  s_cselect_b32 s52, -1, 0
  s_bitcmp1_b32 s10, 1
  s_cselect_b32 s53, -1, 0
  s_mov_b64 s[60:61], s[52:53]
  s_mov_b64 s[54:55], s[52:53]
  s_lshl_b32 s13, s2, 12
  s_add_u32 s13, s13, 3145728
  s_xor_b32 s14, s13, 16384
  v_mov_b32 v30, v230
  s_lshl_b32 s15, s2, 3
  s_add_u32 s15, s15, 1998848
  s_waitcnt lgkmcnt(0)
  s_cmp_eq_u64 s[60:61], 0
  s_cbranch_scc1 L_fk99s
  s_mov_b64 exec, s[60:61]
  buffer_store_dwordx4 v[32:35], v30, s[44:47], s13 offen sc1 nt
  s_waitcnt vmcnt(0)
L_fk99s:
  s_mov_b64 exec, 1
  v_mov_b32 v5, 1
  ds_add_rtn_u32 v6, v1, v5 offset:44088
  s_waitcnt lgkmcnt(0)
  v_readfirstlane_b32 s10, v6
  s_mov_b64 exec, -1
  s_cmp_lg_u32 s10, 7
  s_cbranch_scc1 L_fk99f
  s_bfe_u32 s10, s62, 524296
  s_cbranch_scc0 L_fk99f
  v_mov_b32 v5, s92
  v_lshlrev_b32 v6, 2, v2
  s_mov_b32 exec_lo, 0x3
  s_mov_b32 exec_hi, 0
  buffer_store_dword v5, v6, s[44:47], s15 offen sc1
  s_mov_b64 exec, -1
L_fk99f:
  s_xor_b32 s56, s15, 32
  s_mov_b32 s57, s14
  s_cmp_lg_u32 s72, 3
  s_cbranch_scc1 L_cd109
L_cl108:
  s_add_u32 s96, s96, 1
  s_lshl_b32 s10, s96, 2
  v_mov_b32 v9, s10
  s_mov_b32 s12, 0x100000
L_sp112:
  ds_read_b32 v6, v9 offset:44288
  s_waitcnt lgkmcnt(0)
  v_readfirstlane_b32 s10, v6
  s_cmp_ge_u32 s10, 1
  s_cbranch_scc1 L_sd113
  s_sleep 4
  s_sub_u32 s12, s12, 1
  s_cbranch_scc0 L_sp112
  s_branch L_end
L_sd113:
  s_mov_b32 s97, s10
  s_mul_i32 s13, s96, 640
  s_add_u32 s13, s13, 393216
  s_cmp_ge_u32 s99, 16
  s_cbranch_scc1 L_cp110
  s_lshl_b32 s14, s99, 3
  s_add_u32 s14, s14, s13
  s_add_u32 s14, s14, 640
  v_mov_b32 v12, s92
  v_mov_b32 v13, s97
  s_mov_b64 exec, 1
  buffer_store_dwordx2 v[12:13], v1, s[44:47], s14 offen sc1
  s_mov_b64 exec, -1
L_cp110:
  s_mov_b32 s10, 0
  s_cmp_lt_u32 s96, 2
  s_cbranch_scc1 L_cp110w
  s_load_dwordx8 s[16:23], s[36:37], s13
  s_add_u32 s13, s13, 32
  s_waitcnt lgkmcnt(0)
  s_sub_u32 s11, s97, s17
  s_cmp_eq_u32 s16, s92
  s_cselect_b32 s11, s11, 0
  s_add_u32 s10, s10, s11
  s_sub_u32 s11, s97, s19
  s_cmp_eq_u32 s18, s92
  s_cselect_b32 s11, s11, 0
  s_add_u32 s10, s10, s11
  s_sub_u32 s11, s97, s21
  s_cmp_eq_u32 s20, s92
  s_cselect_b32 s11, s11, 0
  s_add_u32 s10, s10, s11
  s_sub_u32 s11, s97, s23
  s_cmp_eq_u32 s22, s92
  s_cselect_b32 s11, s11, 0
  s_add_u32 s10, s10, s11
  s_load_dwordx8 s[16:23], s[36:37], s13
  s_add_u32 s13, s13, 32
  s_waitcnt lgkmcnt(0)
  s_sub_u32 s11, s97, s17
  s_cmp_eq_u32 s16, s92
  s_cselect_b32 s11, s11, 0
  s_add_u32 s10, s10, s11
  s_sub_u32 s11, s97, s19
  s_cmp_eq_u32 s18, s92
  s_cselect_b32 s11, s11, 0
  s_add_u32 s10, s10, s11
  s_sub_u32 s11, s97, s21
  s_cmp_eq_u32 s20, s92
  s_cselect_b32 s11, s11, 0
  s_add_u32 s10, s10, s11
  s_sub_u32 s11, s97, s23
  s_cmp_eq_u32 s22, s92
  s_cselect_b32 s11, s11, 0
  s_add_u32 s10, s10, s11
  s_load_dwordx8 s[16:23], s[36:37], s13
  s_add_u32 s13, s13, 32
  s_waitcnt lgkmcnt(0)
  s_sub_u32 s11, s97, s17
  s_cmp_eq_u32 s16, s92
  s_cselect_b32 s11, s11, 0
  s_add_u32 s10, s10, s11
  s_sub_u32 s11, s97, s19
  s_cmp_eq_u32 s18, s92
  s_cselect_b32 s11, s11, 0
  s_add_u32 s10, s10, s11
  s_sub_u32 s11, s97, s21
  s_cmp_eq_u32 s20, s92
  s_cselect_b32 s11, s11, 0
  s_add_u32 s10, s10, s11
  s_sub_u32 s11, s97, s23
  s_cmp_eq_u32 s22, s92
  s_cselect_b32 s11, s11, 0
  s_add_u32 s10, s10, s11
  s_load_dwordx8 s[16:23], s[36:37], s13
  s_add_u32 s13, s13, 32
  s_waitcnt lgkmcnt(0)
  s_sub_u32 s11, s97, s17
  s_cmp_eq_u32 s16, s92
  s_cselect_b32 s11, s11, 0
  s_add_u32 s10, s10, s11
  s_sub_u32 s11, s97, s19
  s_cmp_eq_u32 s18, s92
  s_cselect_b32 s11, s11, 0
  s_add_u32 s10, s10, s11
  s_sub_u32 s11, s97, s21
  s_cmp_eq_u32 s20, s92
  s_cselect_b32 s11, s11, 0
  s_add_u32 s10, s10, s11
  s_sub_u32 s11, s97, s23
  s_cmp_eq_u32 s22, s92
  s_cselect_b32 s11, s11, 0
  s_add_u32 s10, s10, s11
L_cp110w:
  s_lshl_b32 s10, s10, 1
  s_lshl_b32 s11, s97, 5
  s_sub_u32 s11, s11, s10
  s_sub_u32 s12, s11, s98
  s_mov_b32 s98, s11
  s_cmp_le_u32 s96, 3
  s_cselect_b32 s12, 10336, s12
  s_mov_b32 s14, s100
  s_mov_b32 s100, s12
  s_cmp_lt_u32 s96, 2
  s_cbranch_scc1 L_cn111
  s_add_u32 s12, s12, s14
  s_lshr_b32 s12, s12, 3
  s_sub_u32 s10, s96, 1
  s_mul_i32 s10, s10, s12
  s_lshl_b32 s10, s10, 2
  s_sub_u32 s11, s11, s10
  s_sub_u32 s11, s11, s101
  v_mov_b32 v12, s11
  v_mov_b32 v13, s12
  ds_write_b64 v1, v[12:13] offset:44072
L_cn111:
  s_cmp_lt_u32 s96, 18
  s_cbranch_scc1 L_cl108
L_cd109:
  s_cmp_eq_u64 s[60:61], 0
  s_cbranch_scc1 L_fk99
  s_mov_b32 s12, 0x100000
L_sp114:
  ds_read_b32 v6, v1 offset:44360
  s_waitcnt lgkmcnt(0)
  v_readfirstlane_b32 s10, v6
  s_cmp_ge_u32 s10, 1
  s_cbranch_scc1 L_sd115
  s_sleep 16
  s_sub_u32 s12, s12, 1
  s_cbranch_scc0 L_sp114
  s_branch L_end
L_sd115:
  s_load_dword s10, s[36:37], s56
  s_waitcnt lgkmcnt(0)
  s_cmp_eq_u32 s10, s92
  s_cbranch_scc1 L_fd98
  s_mov_b32 s12, 0x40000
  s_mov_b64 exec, 1
L_fl97:
  buffer_load_dword v6, v1, s[44:47], s56 offen sc1
  s_waitcnt vmcnt(0)
  v_readfirstlane_b32 s10, v6
  s_cmp_eq_u32 s10, s92
  s_cbranch_scc1 L_fd98
  s_sleep 24
  s_sub_u32 s12, s12, 1
  s_cbranch_scc0 L_fl97
  s_branch L_end
L_fd98:
  s_mov_b64 exec, s[60:61]
  buffer_load_dwordx4 v[36:39], v30, s[44:47], s57 offen sc1 nt
  s_mov_b64 exec, -1
  s_waitcnt vmcnt(0)
  v_cndmask_b32 v32, v32, v36, s[54:55]
  v_cndmask_b32 v33, v33, v37, s[54:55]
  v_cndmask_b32 v34, v34, v38, s[54:55]
  v_cndmask_b32 v35, v35, v39, s[54:55]
L_fk99:
  v_lshlrev_b32 v8, 16, v32
  v_and_b32 v9, 0xffff0000, v32
  v_lshlrev_b32 v10, 16, v33
  v_and_b32 v11, 0xffff0000, v33
  v_lshlrev_b32 v12, 16, v34
  v_and_b32 v13, 0xffff0000, v34
  v_lshlrev_b32 v14, 16, v35
  v_and_b32 v15, 0xffff0000, v35
  v_max3_f32 v24, v8, v9, v10
  v_max3_f32 v24, v24, v11, v12
  v_max3_f32 v24, v24, v13, v14
  v_max_f32 v24, v24, v15
  s_nop 1
  v_max_f32_dpp v24, v24, v24 quad_perm:[1,0,3,2] row_mask:0xf bank_mask:0xf
  s_nop 1
  v_max_f32_dpp v24, v24, v24 quad_perm:[2,3,0,1] row_mask:0xf bank_mask:0xf
  s_nop 1
  v_max_f32_dpp v24, v24, v24 row_half_mirror row_mask:0xf bank_mask:0xf
  s_nop 1
  v_max_f32_dpp v24, v24, v24 row_mirror row_mask:0xf bank_mask:0xf
  v_mov_b32 v25, v24
  s_nop 1
  v_permlane16_swap_b32 v24, v25
  s_nop 1
  v_max_f32 v24, v24, v25
  v_lshrrev_b32 v27, 5, v2
  v_lshl_add_u32 v27, s72, 1, v27
  v_add_u32 v27, 8, v27
  v_cmp_gt_u32 vcc, s26, v27
  v_add_u32 v26, s1, v27
  v_add_u32 v7, s0, v27
  v_cndmask_b32 v26, v26, v7, vcc
  v_cmp_le_u32 vcc, 1376, v26
  v_bfe_u32 v26, v26, 4, 1
  s_nop 0
  v_cndmask_b32 v26, v26, 2, vcc
  v_lshlrev_b32 v26, 5, v26
  v_lshlrev_b32 v27, 2, v27
  ds_read_b32 v25, v26 offset:44416
  s_waitcnt lgkmcnt(0)
  v_max_f32 v24, v24, v25
  s_mov_b32 exec_lo, 1
  s_mov_b32 exec_hi, 1
  ds_max_f32 v26, v24 offset:44432
  s_mov_b64 exec, 1
  v_mov_b32 v5, 1
  ds_add_u32 v1, v5 offset:44056
  s_mov_b64 exec, -1
  s_mov_b32 s12, 0x100000
L_sp116:
  ds_read_b32 v6, v1 offset:44056
  s_waitcnt lgkmcnt(0)
  v_readfirstlane_b32 s10, v6
  s_cmp_ge_u32 s10, 8
  s_cbranch_scc1 L_sd117
  s_sleep 2
  s_sub_u32 s12, s12, 1
  s_cbranch_scc0 L_sp116
  s_branch L_end
L_sd117:
  ds_read_b32 v24, v26 offset:44432
  s_mov_b32 s10, 0x3fb8aa3b
  s_waitcnt lgkmcnt(0)
  v_sub_f32 v25, v25, v24
  v_mul_f32 v25, s10, v25
  v_exp_f32 v25, v25
  s_cmp_lg_u32 s72, 0
  s_cbranch_scc1 L_nofact
  s_mov_b64 exec, 1
  ds_write_b32 v1, v25 offset:44064
  s_mov_b64 exec, -1
L_nofact:
  v_sub_f32 v8, v8, v24
  v_sub_f32 v9, v9, v24
  v_sub_f32 v10, v10, v24
  v_sub_f32 v11, v11, v24
  v_sub_f32 v12, v12, v24
  v_sub_f32 v13, v13, v24
  v_sub_f32 v14, v14, v24
  v_sub_f32 v15, v15, v24
  v_mul_f32 v8, s10, v8
  v_mul_f32 v9, s10, v9
  v_mul_f32 v10, s10, v10
  v_mul_f32 v11, s10, v11
  v_mul_f32 v12, s10, v12
  v_mul_f32 v13, s10, v13
  v_mul_f32 v14, s10, v14
  v_mul_f32 v15, s10, v15
  v_exp_f32 v8, v8
  v_exp_f32 v9, v9
  v_exp_f32 v10, v10
  v_exp_f32 v11, v11
  v_exp_f32 v12, v12
  v_exp_f32 v13, v13
  v_exp_f32 v14, v14
  v_exp_f32 v15, v15
  v_cvt_pk_bf16_f32 v32, v8, v9
  v_cvt_pk_bf16_f32 v33, v10, v11
  v_cvt_pk_bf16_f32 v34, v12, v13
  v_cvt_pk_bf16_f32 v35, v14, v15
  ds_write_b128 v230, v[32:35] offset:12288
  s_mov_b64 exec, 1
  v_mov_b32 v5, 1
  ds_add_u32 v1, v5 offset:44052
  s_mov_b64 exec, -1
  v_add_f32 v8, v8, v12
  v_add_f32 v9, v9, v13
  v_add_f32 v10, v10, v14
  v_add_f32 v11, v11, v15
  v_add_f32 v8, v8, v10
  v_add_f32 v9, v9, v11
  v_add_f32 v8, v8, v9
  s_nop 1
  v_add_f32_dpp v8, v8, v8 quad_perm:[1,0,3,2] row_mask:0xf bank_mask:0xf
  s_nop 1
  v_add_f32_dpp v8, v8, v8 quad_perm:[2,3,0,1] row_mask:0xf bank_mask:0xf
  s_nop 1
  v_add_f32_dpp v8, v8, v8 row_half_mirror row_mask:0xf bank_mask:0xf
  s_nop 1
  v_add_f32_dpp v8, v8, v8 row_mirror row_mask:0xf bank_mask:0xf
  v_mov_b32 v9, v8
  s_nop 1
  v_permlane16_swap_b32 v8, v9
  s_nop 1
  v_add_f32 v8, v8, v9
  ds_write_b32 v27, v8 offset:44160
  s_mov_b64 exec, 1
  v_mov_b32 v5, 1
  ds_add_rtn_u32 v6, v1, v5 offset:44092
  s_waitcnt lgkmcnt(0)
  v_readfirstlane_b32 s10, v6
  s_mov_b64 exec, -1
  s_cmp_lg_u32 s10, 3
  s_cbranch_scc1 L_nostat
  v_lshlrev_b32 v9, 2, v3
  ds_read_b32 v8, v9 offset:44160
  v_cmp_gt_u32 vcc, s26, v3
  v_add_u32 v10, s1, v3
  v_add_u32 v7, s0, v3
  v_cndmask_b32 v10, v10, v7, vcc
  v_cmp_le_u32 vcc, 1376, v10
  v_bfe_u32 v10, v10, 4, 1
  s_nop 0
  v_cndmask_b32 v10, v10, 2, vcc
  v_cmp_eq_u32 vcc, v10, v4
  v_lshlrev_b32 v9, 1, v2
  s_waitcnt lgkmcnt(0)
  v_cndmask_b32 v8, 0, v8, vcc
  s_nop 1
  v_add_f32_dpp v8, v8, v8 quad_perm:[1,0,3,2] row_mask:0xf bank_mask:0xf
  s_nop 1
  v_add_f32_dpp v8, v8, v8 quad_perm:[2,3,0,1] row_mask:0xf bank_mask:0xf
  s_nop 1
  v_add_f32_dpp v8, v8, v8 row_half_mirror row_mask:0xf bank_mask:0xf
  s_mov_b32 exec_lo, 0x01010101
  s_mov_b32 exec_hi, 0x01010101
  ds_write_b32 v9, v8 offset:44424
  s_mov_b64 exec, 0xff
  ds_read_b128 v[24:27], v229 offset:44416
  s_lshl_b32 s13, s27, 1
  s_add_u32 s13, s13, s4
  s_lshl_b32 s13, s13, 7
  s_add_u32 s13, s13, 1835008
  s_waitcnt lgkmcnt(0)
  buffer_store_dwordx4 v[24:27], v229, s[44:47], s13 offen sc1
  s_mov_b64 exec, -1
L_nostat:
  s_cmp_lg_u32 s72, 3
  s_cbranch_scc1 L_pubo
L_cl118:
  s_add_u32 s96, s96, 1
  s_lshl_b32 s10, s96, 2
  v_mov_b32 v9, s10
  s_mov_b32 s12, 0x100000
L_sp122:
  ds_read_b32 v6, v9 offset:44288
  s_waitcnt lgkmcnt(0)
  v_readfirstlane_b32 s10, v6
  s_cmp_ge_u32 s10, 1
  s_cbranch_scc1 L_sd123
  s_sleep 4
  s_sub_u32 s12, s12, 1
  s_cbranch_scc0 L_sp122
  s_branch L_end
L_sd123:
  s_mov_b32 s97, s10
  s_mul_i32 s13, s96, 640
  s_add_u32 s13, s13, 393216
  s_cmp_ge_u32 s99, 16
  s_cbranch_scc1 L_cp120
  s_lshl_b32 s14, s99, 3
  s_add_u32 s14, s14, s13
  s_add_u32 s14, s14, 640
  v_mov_b32 v12, s92
  v_mov_b32 v13, s97
  s_mov_b64 exec, 1
  buffer_store_dwordx2 v[12:13], v1, s[44:47], s14 offen sc1
  s_mov_b64 exec, -1
L_cp120:
  s_mov_b32 s10, 0
  s_cmp_lt_u32 s96, 2
  s_cbranch_scc1 L_cp120w
  s_load_dwordx8 s[16:23], s[36:37], s13
  s_add_u32 s13, s13, 32
  s_waitcnt lgkmcnt(0)
  s_sub_u32 s11, s97, s17
  s_cmp_eq_u32 s16, s92
  s_cselect_b32 s11, s11, 0
  s_add_u32 s10, s10, s11
  s_sub_u32 s11, s97, s19
  s_cmp_eq_u32 s18, s92
  s_cselect_b32 s11, s11, 0
  s_add_u32 s10, s10, s11
  s_sub_u32 s11, s97, s21
  s_cmp_eq_u32 s20, s92
  s_cselect_b32 s11, s11, 0
  s_add_u32 s10, s10, s11
  s_sub_u32 s11, s97, s23
  s_cmp_eq_u32 s22, s92
  s_cselect_b32 s11, s11, 0
  s_add_u32 s10, s10, s11
  s_load_dwordx8 s[16:23], s[36:37], s13
  s_add_u32 s13, s13, 32
  s_waitcnt lgkmcnt(0)
  s_sub_u32 s11, s97, s17
  s_cmp_eq_u32 s16, s92
  s_cselect_b32 s11, s11, 0
  s_add_u32 s10, s10, s11
  s_sub_u32 s11, s97, s19
  s_cmp_eq_u32 s18, s92
  s_cselect_b32 s11, s11, 0
  s_add_u32 s10, s10, s11
  s_sub_u32 s11, s97, s21
  s_cmp_eq_u32 s20, s92
  s_cselect_b32 s11, s11, 0
  s_add_u32 s10, s10, s11
  s_sub_u32 s11, s97, s23
  s_cmp_eq_u32 s22, s92
  s_cselect_b32 s11, s11, 0
  s_add_u32 s10, s10, s11
  s_load_dwordx8 s[16:23], s[36:37], s13
  s_add_u32 s13, s13, 32
  s_waitcnt lgkmcnt(0)
  s_sub_u32 s11, s97, s17
  s_cmp_eq_u32 s16, s92
  s_cselect_b32 s11, s11, 0
  s_add_u32 s10, s10, s11
  s_sub_u32 s11, s97, s19
  s_cmp_eq_u32 s18, s92
  s_cselect_b32 s11, s11, 0
  s_add_u32 s10, s10, s11
  s_sub_u32 s11, s97, s21
  s_cmp_eq_u32 s20, s92
  s_cselect_b32 s11, s11, 0
  s_add_u32 s10, s10, s11
  s_sub_u32 s11, s97, s23
  s_cmp_eq_u32 s22, s92
  s_cselect_b32 s11, s11, 0
  s_add_u32 s10, s10, s11
  s_load_dwordx8 s[16:23], s[36:37], s13
  s_add_u32 s13, s13, 32
  s_waitcnt lgkmcnt(0)
  s_sub_u32 s11, s97, s17
  s_cmp_eq_u32 s16, s92
  s_cselect_b32 s11, s11, 0
  s_add_u32 s10, s10, s11
  s_sub_u32 s11, s97, s19
  s_cmp_eq_u32 s18, s92
  s_cselect_b32 s11, s11, 0
  s_add_u32 s10, s10, s11
  s_sub_u32 s11, s97, s21
  s_cmp_eq_u32 s20, s92
  s_cselect_b32 s11, s11, 0
  s_add_u32 s10, s10, s11
  s_sub_u32 s11, s97, s23
  s_cmp_eq_u32 s22, s92
  s_cselect_b32 s11, s11, 0
  s_add_u32 s10, s10, s11
L_cp120w:
  s_lshl_b32 s10, s10, 1
  s_lshl_b32 s11, s97, 5
  s_sub_u32 s11, s11, s10
  s_sub_u32 s12, s11, s98
  s_mov_b32 s98, s11
  s_cmp_le_u32 s96, 3
  s_cselect_b32 s12, 10336, s12
  s_mov_b32 s14, s100
  s_mov_b32 s100, s12
  s_cmp_lt_u32 s96, 2
  s_cbranch_scc1 L_cn121
  s_add_u32 s12, s12, s14
  s_lshr_b32 s12, s12, 3
  s_sub_u32 s10, s96, 1
  s_mul_i32 s10, s10, s12
  s_lshl_b32 s10, s10, 2
  s_sub_u32 s11, s11, s10
  s_sub_u32 s11, s11, s101
  v_mov_b32 v12, s11
  v_mov_b32 v13, s12
  ds_write_b64 v1, v[12:13] offset:44072
L_cn121:
  s_cmp_lt_u32 s96, 24
  s_cbranch_scc1 L_cl118
L_cd119:
  v_bfe_u32 v12, v2, 1, 3
  v_lshlrev_b32 v12, 7, v12
  v_lshl_add_u32 v12, v4, 5, v12
  v_and_b32 v13, 1, v2
  v_lshl_add_u32 v12, v13, 4, v12
  v_mov_b32 v8, 0xff7f0000
  v_mov_b32 v10, 0
  s_sub_u32 s13, s27, s94
  s_lshl_b32 s13, s13, 8
  s_add_u32 s13, s13, 1835008
  s_mov_b32 s10, 0x00ff00ff
  s_cmp_lt_u32 s27, 126
  s_cselect_b32 exec_lo, 0x0fff0fff, s10
  s_mov_b32 exec_hi, exec_lo
  s_mov_b32 s12, 0x40000
L_sl124:
  buffer_load_dwordx4 v[8:11], v12, s[44:47], s13 offen sc1
  s_waitcnt vmcnt(0)
  v_xor_b32 v13, s92, v9
  v_bitop3_b32 v13, v13, v11, s92 bitop3:0xf6
  v_cmp_ne_u32 vcc, 0, v13
  s_cmp_eq_u64 vcc, 0
  s_cbranch_scc1 L_sd125
  s_sleep 24
  s_sub_u32 s12, s12, 1
  s_cbranch_scc0 L_sl124
  s_branch L_end
L_sd125:
  s_mov_b64 exec, -1
  v_max_f32_dpp v13, v8, v8 quad_perm:[1,0,3,2] row_mask:0xf bank_mask:0xf
  v_mov_b32 v9, v8
  s_nop 1
  v_max_f32_dpp v9, v9, v9 quad_perm:[1,0,3,2] row_mask:0xf bank_mask:0xf
  s_nop 1
  v_max_f32_dpp v9, v9, v9 quad_perm:[2,3,0,1] row_mask:0xf bank_mask:0xf
  s_nop 1
  v_max_f32_dpp v9, v9, v9 row_half_mirror row_mask:0xf bank_mask:0xf
  s_nop 1
  v_max_f32_dpp v9, v9, v9 row_mirror row_mask:0xf bank_mask:0xf
  v_sub_f32 v8, v8, v9
  v_sub_f32 v13, v13, v9
  v_mul_f32 v8, 0x3fb8aa3b, v8
  v_mul_f32 v13, 0x3fb8aa3b, v13
  v_exp_f32 v8, v8
  v_exp_f32 v13, v13
  v_mul_f32 v10, v10, v8
  s_nop 1
  v_add_f32_dpp v10, v10, v10 quad_perm:[1,0,3,2] row_mask:0xf bank_mask:0xf
  s_nop 1
  v_add_f32_dpp v10, v10, v10 quad_perm:[2,3,0,1] row_mask:0xf bank_mask:0xf
  s_nop 1
  v_add_f32_dpp v10, v10, v10 row_half_mirror row_mask:0xf bank_mask:0xf
  s_nop 1
  v_add_f32_dpp v10, v10, v10 row_mirror row_mask:0xf bank_mask:0xf
  v_rcp_f32 v10, v10
  v_lshlrev_b32 v11, 3, v4
  v_mul_f32 v9, v13, v10
  v_mov_b32 v8, 1
  s_lshl_b32 s10, s94, 1
  s_add_u32 s10, s10, s4
  s_lshl_b32 s10, s10, 1
  s_lshl_b32 exec_lo, 0x10001, s10
  s_mov_b32 exec_hi, exec_lo
  ds_write_b64 v11, v[8:9] offset:44224
  s_mov_b64 exec, -1
  s_cmp_ge_u32 s96, 27
  s_cbranch_scc1 L_cd127
L_cl126:
  s_add_u32 s96, s96, 1
  s_lshl_b32 s10, s96, 2
  v_mov_b32 v9, s10
  s_mov_b32 s12, 0x100000
L_sp130:
  ds_read_b32 v6, v9 offset:44288
  s_waitcnt lgkmcnt(0)
  v_readfirstlane_b32 s10, v6
  s_cmp_ge_u32 s10, 1
  s_cbranch_scc1 L_sd131
  s_sleep 4
  s_sub_u32 s12, s12, 1
  s_cbranch_scc0 L_sp130
  s_branch L_end
L_sd131:
  s_mov_b32 s97, s10
  s_mul_i32 s13, s96, 640
  s_add_u32 s13, s13, 393216
  s_cmp_ge_u32 s99, 16
  s_cbranch_scc1 L_cp128
  s_lshl_b32 s14, s99, 3
  s_add_u32 s14, s14, s13
  s_add_u32 s14, s14, 640
  v_mov_b32 v12, s92
  v_mov_b32 v13, s97
  s_mov_b64 exec, 1
  buffer_store_dwordx2 v[12:13], v1, s[44:47], s14 offen sc1
  s_mov_b64 exec, -1
L_cp128:
  s_mov_b32 s10, 0
  s_cmp_lt_u32 s96, 2
  s_cbranch_scc1 L_cp128w
  s_load_dwordx8 s[16:23], s[36:37], s13
  s_add_u32 s13, s13, 32
  s_waitcnt lgkmcnt(0)
  s_sub_u32 s11, s97, s17
  s_cmp_eq_u32 s16, s92
  s_cselect_b32 s11, s11, 0
  s_add_u32 s10, s10, s11
  s_sub_u32 s11, s97, s19
  s_cmp_eq_u32 s18, s92
  s_cselect_b32 s11, s11, 0
  s_add_u32 s10, s10, s11
  s_sub_u32 s11, s97, s21
  s_cmp_eq_u32 s20, s92
  s_cselect_b32 s11, s11, 0
  s_add_u32 s10, s10, s11
  s_sub_u32 s11, s97, s23
  s_cmp_eq_u32 s22, s92
  s_cselect_b32 s11, s11, 0
  s_add_u32 s10, s10, s11
  s_load_dwordx8 s[16:23], s[36:37], s13
  s_add_u32 s13, s13, 32
  s_waitcnt lgkmcnt(0)
  s_sub_u32 s11, s97, s17
  s_cmp_eq_u32 s16, s92
  s_cselect_b32 s11, s11, 0
  s_add_u32 s10, s10, s11
  s_sub_u32 s11, s97, s19
  s_cmp_eq_u32 s18, s92
  s_cselect_b32 s11, s11, 0
  s_add_u32 s10, s10, s11
  s_sub_u32 s11, s97, s21
  s_cmp_eq_u32 s20, s92
  s_cselect_b32 s11, s11, 0
  s_add_u32 s10, s10, s11
  s_sub_u32 s11, s97, s23
  s_cmp_eq_u32 s22, s92
  s_cselect_b32 s11, s11, 0
  s_add_u32 s10, s10, s11
  s_load_dwordx8 s[16:23], s[36:37], s13
  s_add_u32 s13, s13, 32
  s_waitcnt lgkmcnt(0)
  s_sub_u32 s11, s97, s17
  s_cmp_eq_u32 s16, s92
  s_cselect_b32 s11, s11, 0
  s_add_u32 s10, s10, s11
  s_sub_u32 s11, s97, s19
  s_cmp_eq_u32 s18, s92
  s_cselect_b32 s11, s11, 0
  s_add_u32 s10, s10, s11
  s_sub_u32 s11, s97, s21
  s_cmp_eq_u32 s20, s92
  s_cselect_b32 s11, s11, 0
  s_add_u32 s10, s10, s11
  s_sub_u32 s11, s97, s23
  s_cmp_eq_u32 s22, s92
  s_cselect_b32 s11, s11, 0
  s_add_u32 s10, s10, s11
  s_load_dwordx8 s[16:23], s[36:37], s13
  s_add_u32 s13, s13, 32
  s_waitcnt lgkmcnt(0)
  s_sub_u32 s11, s97, s17
  s_cmp_eq_u32 s16, s92
  s_cselect_b32 s11, s11, 0
  s_add_u32 s10, s10, s11
  s_sub_u32 s11, s97, s19
  s_cmp_eq_u32 s18, s92
  s_cselect_b32 s11, s11, 0
  s_add_u32 s10, s10, s11
  s_sub_u32 s11, s97, s21
  s_cmp_eq_u32 s20, s92
  s_cselect_b32 s11, s11, 0
  s_add_u32 s10, s10, s11
  s_sub_u32 s11, s97, s23
  s_cmp_eq_u32 s22, s92
  s_cselect_b32 s11, s11, 0
  s_add_u32 s10, s10, s11
L_cp128w:
  s_lshl_b32 s10, s10, 1
  s_lshl_b32 s11, s97, 5
  s_sub_u32 s11, s11, s10
  s_sub_u32 s12, s11, s98
  s_mov_b32 s98, s11
  s_cmp_le_u32 s96, 3
  s_cselect_b32 s12, 10336, s12
  s_mov_b32 s14, s100
  s_mov_b32 s100, s12
  s_cmp_lt_u32 s96, 2
  s_cbranch_scc1 L_cn129
  s_add_u32 s12, s12, s14
  s_lshr_b32 s12, s12, 3
  s_sub_u32 s10, s96, 1
  s_mul_i32 s10, s10, s12
  s_lshl_b32 s10, s10, 2
  s_sub_u32 s11, s11, s10
  s_sub_u32 s11, s11, s101
  v_mov_b32 v12, s11
  v_mov_b32 v13, s12
  ds_write_b64 v1, v[12:13] offset:44072
L_cn129:
  s_cmp_lt_u32 s96, 27
  s_cbranch_scc1 L_cl126
L_cd127:
L_cl132:
  s_add_u32 s96, s96, 1
  s_lshl_b32 s10, s96, 2
  v_mov_b32 v9, s10
  s_mov_b32 s12, 0x100000
L_sp136:
  ds_read_b32 v6, v9 offset:44288
  s_waitcnt lgkmcnt(0)
  v_readfirstlane_b32 s10, v6
  s_cmp_ge_u32 s10, 1
  s_cbranch_scc1 L_sd137
  s_sleep 4
  s_sub_u32 s12, s12, 1
  s_cbranch_scc0 L_sp136
  s_branch L_end
L_sd137:
  s_mov_b32 s97, s10
  s_mul_i32 s13, s96, 640
  s_add_u32 s13, s13, 393216
  s_cmp_ge_u32 s99, 16
  s_cbranch_scc1 L_cp134
  s_lshl_b32 s14, s99, 3
  s_add_u32 s14, s14, s13
  s_add_u32 s14, s14, 640
  v_mov_b32 v12, s92
  v_mov_b32 v13, s97
  s_mov_b64 exec, 1
  buffer_store_dwordx2 v[12:13], v1, s[44:47], s14 offen sc1
  s_mov_b64 exec, -1
L_cp134:
  s_mov_b32 s10, 0
  s_cmp_lt_u32 s96, 2
  s_cbranch_scc1 L_cp134w
  s_load_dwordx8 s[16:23], s[36:37], s13
  s_add_u32 s13, s13, 32
  s_waitcnt lgkmcnt(0)
  s_sub_u32 s11, s97, s17
  s_cmp_eq_u32 s16, s92
  s_cselect_b32 s11, s11, 0
  s_add_u32 s10, s10, s11
  s_sub_u32 s11, s97, s19
  s_cmp_eq_u32 s18, s92
  s_cselect_b32 s11, s11, 0
  s_add_u32 s10, s10, s11
  s_sub_u32 s11, s97, s21
  s_cmp_eq_u32 s20, s92
  s_cselect_b32 s11, s11, 0
  s_add_u32 s10, s10, s11
  s_sub_u32 s11, s97, s23
  s_cmp_eq_u32 s22, s92
  s_cselect_b32 s11, s11, 0
  s_add_u32 s10, s10, s11
  s_load_dwordx8 s[16:23], s[36:37], s13
  s_add_u32 s13, s13, 32
  s_waitcnt lgkmcnt(0)
  s_sub_u32 s11, s97, s17
  s_cmp_eq_u32 s16, s92
  s_cselect_b32 s11, s11, 0
  s_add_u32 s10, s10, s11
  s_sub_u32 s11, s97, s19
  s_cmp_eq_u32 s18, s92
  s_cselect_b32 s11, s11, 0
  s_add_u32 s10, s10, s11
  s_sub_u32 s11, s97, s21
  s_cmp_eq_u32 s20, s92
  s_cselect_b32 s11, s11, 0
  s_add_u32 s10, s10, s11
  s_sub_u32 s11, s97, s23
  s_cmp_eq_u32 s22, s92
  s_cselect_b32 s11, s11, 0
  s_add_u32 s10, s10, s11
  s_load_dwordx8 s[16:23], s[36:37], s13
  s_add_u32 s13, s13, 32
  s_waitcnt lgkmcnt(0)
  s_sub_u32 s11, s97, s17
  s_cmp_eq_u32 s16, s92
  s_cselect_b32 s11, s11, 0
  s_add_u32 s10, s10, s11
  s_sub_u32 s11, s97, s19
  s_cmp_eq_u32 s18, s92
  s_cselect_b32 s11, s11, 0
  s_add_u32 s10, s10, s11
  s_sub_u32 s11, s97, s21
  s_cmp_eq_u32 s20, s92
  s_cselect_b32 s11, s11, 0
  s_add_u32 s10, s10, s11
  s_sub_u32 s11, s97, s23
  s_cmp_eq_u32 s22, s92
  s_cselect_b32 s11, s11, 0
  s_add_u32 s10, s10, s11
  s_load_dwordx8 s[16:23], s[36:37], s13
  s_add_u32 s13, s13, 32
  s_waitcnt lgkmcnt(0)
  s_sub_u32 s11, s97, s17
  s_cmp_eq_u32 s16, s92
  s_cselect_b32 s11, s11, 0
  s_add_u32 s10, s10, s11
  s_sub_u32 s11, s97, s19
  s_cmp_eq_u32 s18, s92
  s_cselect_b32 s11, s11, 0
  s_add_u32 s10, s10, s11
  s_sub_u32 s11, s97, s21
  s_cmp_eq_u32 s20, s92
  s_cselect_b32 s11, s11, 0
  s_add_u32 s10, s10, s11
  s_sub_u32 s11, s97, s23
  s_cmp_eq_u32 s22, s92
  s_cselect_b32 s11, s11, 0
  s_add_u32 s10, s10, s11
L_cp134w:
  s_lshl_b32 s10, s10, 1
  s_lshl_b32 s11, s97, 5
  s_sub_u32 s11, s11, s10
  s_sub_u32 s12, s11, s98
  s_mov_b32 s98, s11
  s_cmp_le_u32 s96, 3
  s_cselect_b32 s12, 10336, s12
  s_mov_b32 s14, s100
  s_mov_b32 s100, s12
  s_cmp_lt_u32 s96, 2
  s_cbranch_scc1 L_cn135
  s_add_u32 s12, s12, s14
  s_lshr_b32 s12, s12, 3
  s_sub_u32 s10, s96, 1
  s_mul_i32 s10, s10, s12
  s_lshl_b32 s10, s10, 2
  s_sub_u32 s11, s11, s10
  s_sub_u32 s11, s11, s101
  v_mov_b32 v12, s11
  v_mov_b32 v13, s12
  ds_write_b64 v1, v[12:13] offset:44072
L_cn135:
  s_cmp_lt_u32 s96, 29
  s_cbranch_scc1 L_cl132
L_cd133:
  s_cmp_lg_u32 s76, 0
  s_cbranch_scc1 L_end
  v_lshrrev_b32 v52, 2, v2
  v_mul_u32_u24 v52, 10240, v52
  v_and_b32 v5, 3, v2
  v_lshl_add_u32 v52, v5, 4, v52
  v_mul_u32_u24 v53, 1280, v4
  v_lshl_add_u32 v53, v5, 1, v53
  s_lshl_b32 s62, s39, 5
  s_add_u32 s62, s62, s77
  s_lshl_b32 s16, s62, 6
  s_add_u32 s16, s16, 1310720
  s_add_u32 s17, s16, 163840
  s_add_u32 s18, s16, 327680
  s_lshl_b32 s62, s62, 3
  buffer_load_ushort v54, v53, s[48:51], s62 offen
  v_mov_b32 v40, 0
  v_mov_b32 v41, 0
  v_mov_b32 v42, 0
  v_mov_b32 v43, 0
  s_mov_b32 exec_hi, 0
  s_mov_b32 s12, 0x40000
L_pl138:
  buffer_load_dwordx4 v[40:43], v52, s[44:47], s18 offen sc1
  s_waitcnt vmcnt(0)
  v_xor_b32 v5, v40, v236
  v_bitop3_b32 v5, v5, v41, v237 bitop3:0xf6
  v_bitop3_b32 v5, v5, v42, v238 bitop3:0xf6
  v_bitop3_b32 v5, v5, v43, v239 bitop3:0xf6
  v_and_b32 v40, -16, v40
  v_and_b32 v41, -16, v41
  v_and_b32 v42, -16, v42
  v_and_b32 v43, -16, v43
  v_and_b32 v5, 15, v5
  v_cmp_ne_u32 vcc, 0, v5
  s_cmp_eq_u64 vcc, 0
  s_cbranch_scc1 L_pd139
  s_sleep 16
  s_sub_u32 s12, s12, 1
  s_cbranch_scc0 L_pl138
  s_branch L_end
L_pd139:
  s_mov_b32 exec_hi, -1
  s_nop 1
  v_permlane16_swap_b32 v40, v41
  v_permlane16_swap_b32 v42, v43
  s_nop 0
  v_add_f32 v40, v40, v41
  v_add_f32 v42, v42, v43
  s_nop 1
  v_permlane32_swap_b32 v40, v42
  s_nop 0
  v_add_f32 v40, v40, v42
  s_nop 1
  v_add_f32_dpp v40, v40, v40 row_ror:4 row_mask:0xf bank_mask:0xf
  s_nop 1
  v_add_f32_dpp v40, v40, v40 row_ror:8 row_mask:0xf bank_mask:0xf
  v_cvt_pk_bf16_f32 v40, v40, v40
  v_lshlrev_b32 v40, 16, v40
  v_lshlrev_b32 v46, 16, v54
  s_mov_b32 s12, 0x100000
L_sp140:
  ds_read_b32 v6, v1 offset:44104
  s_waitcnt lgkmcnt(0)
  v_readfirstlane_b32 s10, v6
  s_cmp_ge_u32 s10, 1
  s_cbranch_scc1 L_sd141
  s_sleep 1
  s_sub_u32 s12, s12, 1
  s_cbranch_scc0 L_sp140
  s_branch L_end
L_sd141:
  s_setprio 3
L_tl142:
  s_waitcnt vmcnt(31)
  buffer_load_dwordx4 v232, s[40:43], s70 offen nt lds
  s_add_u32 m0, m0, 1088
  s_add_u32 s70, s70, 5120
  s_cmp_lt_u32 s70, s71
  s_cbranch_scc1 L_tl142
  buffer_load_dwordx4 v[8:11], v52, s[44:47], s16 offen sc1
  buffer_load_dwordx4 v[12:15], v52, s[44:47], s17 offen sc1
  s_waitcnt vmcnt(0)
  s_mov_b64 exec, 1
  v_mov_b32 v5, 1
  ds_add_u32 v1, v5 offset:44036
  s_mov_b64 exec, -1
  s_branch L_frag
L_pubo:
  v_mov_b32 v52, 0
  v_mov_b32 v53, 0
  s_bcnt1_i32_b32 s10, s95
  s_add_u32 s10, s10, s72
  s_cmp_lt_u32 s10, 3
  s_cbranch_scc1 L_pubdone
  s_cmp_eq_u32 s72, 2
  s_cbranch_scc1 L_pubdone
  s_mul_i32 s10, s72, 6144
  v_add_u32 v40, s10, v229
  v_mov_b32 v42, v229
  s_lshl_b32 s10, s69, 3
  v_mov_b32 v45, s10
  s_cmp_lg_u32 s94, 1
  s_cselect_b32 s10, 1, 0
  s_cmp_eq_u32 s69, 1
  s_cselect_b32 s10, s10, s94
  s_lshl_b32 s13, s68, 2
  s_add_u32 s13, s13, s10
  s_lshl_b32 s13, s13, 1
  s_add_u32 s13, s13, s4
  s_lshl_b32 s13, s13, 10
  s_add_u32 s13, s13, 4194304
  s_mov_b32 s12, 0x100000
L_sp143:
  ds_read_b64 v[6:7], v45 offset:44224
  s_waitcnt lgkmcnt(0)
  v_readfirstlane_b32 s10, v6
  v_readfirstlane_b32 s11, v7
  s_cmp_ge_u32 s10, 1
  s_cbranch_scc1 L_sd144
  s_sleep 16
  s_sub_u32 s12, s12, 1
  s_cbranch_scc0 L_sp143
  s_branch L_end
L_sd144:
  s_mov_b32 s73, s11
  v_mov_b32 v44, v236
  v_mov_b32 v45, v237
  v_mov_b32 v46, v238
  v_mov_b32 v47, v239
  s_mov_b32 s12, 0x100000
L_sp145:
  ds_read_b32 v6, v231 offset:44096
  s_waitcnt lgkmcnt(0)
  v_readfirstlane_b32 s10, v6
  s_cmp_ge_u32 s10, 4
  s_cbranch_scc1 L_sd146
  s_sleep 8
  s_sub_u32 s12, s12, 1
  s_cbranch_scc0 L_sp145
  s_branch L_end
L_sd146:
  s_mov_b32 s12, 0x100000
L_sp147:
  ds_read_b32 v6, v1 offset:44408
  s_waitcnt lgkmcnt(0)
  v_readfirstlane_b32 s10, v6
  s_cmp_ge_u32 s10, 1
  s_cbranch_scc1 L_sd148
  s_sleep 4
  s_sub_u32 s12, s12, 1
  s_cbranch_scc0 L_sp147
  s_branch L_end
L_sd148:
  s_branch L_pub
L_pubdone:
  s_cmp_lg_u32 s76, 0
  s_cbranch_scc1 L_end
  s_mov_b32 s63, 0
  s_lshl_b32 s16, s77, 13
  s_lshl_b32 s10, s72, 8
  s_add_u32 s16, s16, s10
  s_add_u32 s16, s16, 4194304
  s_add_u32 s17, s16, 0x40000
  s_add_u32 s18, s16, 0x80000
  s_add_u32 s19, s16, 0xc0000
  s_cmp_ge_u32 s77, 22
  s_cselect_b32 s20, -1, 0
  v_lshlrev_b32 v47, 10, v4
  v_lshl_add_u32 v47, v3, 4, v47
  v_lshrrev_b32 v48, 1, v4
  v_mul_u32_u24 v48, 0x40800, v48
  v_sub_u32 v48, 0x41000, v48
  v_add_u32 v48, v48, v47
  v_lshlrev_b32 v44, 3, v3
  v_lshl_add_u32 v44, v4, 1, v44
  s_lshl_b32 s10, s72, 7
  v_add_u32 v44, s10, v44
  v_mov_b32 v24, 0
  v_mov_b32 v25, 0
  v_mov_b32 v26, 0
  v_mov_b32 v27, 0
  s_mov_b32 s12, 0x100000
L_sp149:
  ds_read_b32 v6, v1 offset:44104
  s_waitcnt lgkmcnt(0)
  v_readfirstlane_b32 s10, v6
  s_cmp_ge_u32 s10, 4
  s_cbranch_scc1 L_sd150
  s_sleep 1
  s_sub_u32 s12, s12, 1
  s_cbranch_scc0 L_sp149
  s_branch L_end
L_sd150:
  s_setprio 3
  s_mov_b32 s12, 0x40000
L_pl151:
  buffer_load_dwordx4 v[8:11], v47, s[44:47], s16 offen sc1
  buffer_load_dwordx4 v[12:15], v47, s[44:47], s17 offen sc1
  s_waitcnt vmcnt(1)
  v_xor_b32 v5, v8, v236
  v_bitop3_b32 v5, v5, v9, v237 bitop3:0xf6
  v_bitop3_b32 v5, v5, v10, v238 bitop3:0xf6
  v_bitop3_b32 v5, v5, v11, v239 bitop3:0xf6
  v_and_b32 v8, -16, v8
  v_and_b32 v9, -16, v9
  v_and_b32 v10, -16, v10
  v_and_b32 v11, -16, v11
  s_waitcnt vmcnt(0)
  v_bitop3_b32 v5, v5, v12, v236 bitop3:0xf6
  v_bitop3_b32 v5, v5, v13, v237 bitop3:0xf6
  v_bitop3_b32 v5, v5, v14, v238 bitop3:0xf6
  v_bitop3_b32 v5, v5, v15, v239 bitop3:0xf6
  v_and_b32 v12, -16, v12
  v_and_b32 v13, -16, v13
  v_and_b32 v14, -16, v14
  v_and_b32 v15, -16, v15
  v_and_b32 v5, 15, v5
  v_cmp_ne_u32 vcc, 0, v5
  s_nop 1
  v_permlane16_swap_b32 v8, v9
  v_permlane16_swap_b32 v10, v11
  v_permlane16_swap_b32 v12, v13
  v_permlane16_swap_b32 v14, v15
  s_nop 0
  v_add_f32 v8, v8, v9
  v_add_f32 v10, v10, v11
  v_add_f32 v12, v12, v13
  v_add_f32 v14, v14, v15
  s_nop 1
  v_permlane32_swap_b32 v8, v10
  v_permlane32_swap_b32 v12, v14
  s_nop 0
  v_add_f32 v8, v8, v10
  v_add_f32 v12, v12, v14
  v_cvt_pk_bf16_f32 v8, v8, v8
  ds_write_b16 v44, v8 offset:40960
  v_cvt_pk_bf16_f32 v12, v12, v12
  ds_write_b16 v44, v12 offset:41344
  s_cmp_eq_u64 vcc, 0
  s_cbranch_scc1 L_pd152
  s_sleep 4
  s_sub_u32 s12, s12, 1
  s_cbranch_scc0 L_pl151
  s_branch L_end
L_pd152:
  s_mov_b32 s12, 0x40000
L_pl153:
  buffer_load_dwordx4 v[16:19], v47, s[44:47], s18 offen sc1
  buffer_load_dwordx4 v[20:23], v47, s[44:47], s19 offen sc1
  s_mov_b32 exec_hi, s20
  buffer_load_dwordx4 v[24:27], v48, s[44:47], s18 offen sc1
  s_mov_b32 exec_hi, -1
  s_cmp_lg_u32 s63, 0
  s_cbranch_scc1 L_nofrag
  ds_read_b32 v6, v1 offset:44036
  s_waitcnt lgkmcnt(0)
  v_readfirstlane_b32 s63, v6
  s_cmp_eq_u32 s63, 0
  s_cbranch_scc1 L_nofrag
  ds_read_b64_tr_b16 v[180:181], v234 offset:0
  ds_read_b64_tr_b16 v[182:183], v234 offset:1088
  ds_read_b64_tr_b16 v[184:185], v235 offset:0
  ds_read_b64_tr_b16 v[186:187], v235 offset:1088
  ds_read_b64_tr_b16 v[188:189], v234 offset:8704
  ds_read_b64_tr_b16 v[190:191], v234 offset:9792
  ds_read_b64_tr_b16 v[192:193], v235 offset:8704
  ds_read_b64_tr_b16 v[194:195], v235 offset:9792
  ds_read_b64_tr_b16 v[196:197], v234 offset:17408
  ds_read_b64_tr_b16 v[198:199], v234 offset:18496
  ds_read_b64_tr_b16 v[200:201], v235 offset:17408
  ds_read_b64_tr_b16 v[202:203], v235 offset:18496
  ds_read_b64_tr_b16 v[204:205], v234 offset:26112
  ds_read_b64_tr_b16 v[206:207], v234 offset:27200
  ds_read_b64_tr_b16 v[208:209], v235 offset:26112
  ds_read_b64_tr_b16 v[210:211], v235 offset:27200
  ds_read_b64_tr_b16 v[212:213], v234 offset:34816
  ds_read_b64_tr_b16 v[214:215], v234 offset:35904
  ds_read_b64_tr_b16 v[216:217], v235 offset:34816
  ds_read_b64_tr_b16 v[218:219], v235 offset:35904
  ds_read_b64_tr_b16 v[220:221], v234 offset:43520
  ds_read_b64_tr_b16 v[222:223], v234 offset:44608
  ds_read_b64_tr_b16 v[224:225], v235 offset:43520
  ds_read_b64_tr_b16 v[226:227], v235 offset:44608
L_nofrag:
  s_waitcnt vmcnt(2)
  v_xor_b32 v5, v16, v236
  v_bitop3_b32 v5, v5, v17, v237 bitop3:0xf6
  v_bitop3_b32 v5, v5, v18, v238 bitop3:0xf6
  v_bitop3_b32 v5, v5, v19, v239 bitop3:0xf6
  v_and_b32 v16, -16, v16
  v_and_b32 v17, -16, v17
  v_and_b32 v18, -16, v18
  v_and_b32 v19, -16, v19
  s_waitcnt vmcnt(1)
  v_bitop3_b32 v5, v5, v20, v236 bitop3:0xf6
  v_bitop3_b32 v5, v5, v21, v237 bitop3:0xf6
  v_bitop3_b32 v5, v5, v22, v238 bitop3:0xf6
  v_bitop3_b32 v5, v5, v23, v239 bitop3:0xf6
  v_and_b32 v20, -16, v20
  v_and_b32 v21, -16, v21
  v_and_b32 v22, -16, v22
  v_and_b32 v23, -16, v23
  s_waitcnt vmcnt(0)
  s_mov_b32 exec_hi, s20
  v_bitop3_b32 v5, v5, v24, v236 bitop3:0xf6
  v_bitop3_b32 v5, v5, v25, v237 bitop3:0xf6
  v_bitop3_b32 v5, v5, v26, v238 bitop3:0xf6
  v_bitop3_b32 v5, v5, v27, v239 bitop3:0xf6
  v_and_b32 v24, -16, v24
  v_and_b32 v25, -16, v25
  v_and_b32 v26, -16, v26
  v_and_b32 v27, -16, v27
  s_mov_b32 exec_hi, -1
  v_and_b32 v5, 15, v5
  v_cmp_ne_u32 vcc, 0, v5
  s_nop 1
  v_permlane16_swap_b32 v16, v17
  v_permlane16_swap_b32 v18, v19
  v_permlane16_swap_b32 v20, v21
  v_permlane16_swap_b32 v22, v23
  v_permlane16_swap_b32 v24, v25
  v_permlane16_swap_b32 v26, v27
  s_nop 0
  v_add_f32 v16, v16, v17
  v_add_f32 v18, v18, v19
  v_add_f32 v20, v20, v21
  v_add_f32 v22, v22, v23
  v_add_f32 v24, v24, v25
  v_add_f32 v26, v26, v27
  s_mov_b32 exec_hi, 0
  v_add_f32 v20, v20, v24
  v_add_f32 v22, v22, v26
  s_mov_b32 exec_lo, 0
  s_mov_b32 exec_hi, -1
  v_add_f32 v16, v16, v24
  v_add_f32 v18, v18, v26
  s_mov_b32 exec_lo, -1
  s_nop 1
  v_permlane32_swap_b32 v16, v18
  v_permlane32_swap_b32 v20, v22
  s_nop 0
  v_add_f32 v16, v16, v18
  v_add_f32 v20, v20, v22
  v_cvt_pk_bf16_f32 v16, v16, v16
  ds_write_b16 v44, v16 offset:41728
  v_cvt_pk_bf16_f32 v20, v20, v20
  ds_write_b16 v44, v20 offset:42112
  s_cmp_eq_u64 vcc, 0
  s_cbranch_scc1 L_pd154
  s_sub_u32 s12, s12, 1
  s_cbranch_scc0 L_pl153
  s_branch L_end
L_pd154:
  s_cmp_lg_u32 s63, 0
  s_cbranch_scc1 L_proj
L_fragwait:
  s_mov_b32 s12, 0x100000
L_sp155:
  ds_read_b32 v6, v1 offset:44036
  s_waitcnt lgkmcnt(0)
  v_readfirstlane_b32 s10, v6
  s_cmp_ge_u32 s10, 1
  s_cbranch_scc1 L_sd156
  s_sleep 0
  s_sub_u32 s12, s12, 1
  s_cbranch_scc0 L_sp155
  s_branch L_end
L_sd156:
L_frag:
  ds_read_b64_tr_b16 v[180:181], v234 offset:0
  ds_read_b64_tr_b16 v[182:183], v234 offset:1088
  ds_read_b64_tr_b16 v[184:185], v235 offset:0
  ds_read_b64_tr_b16 v[186:187], v235 offset:1088
  ds_read_b64_tr_b16 v[188:189], v234 offset:8704
  ds_read_b64_tr_b16 v[190:191], v234 offset:9792
  ds_read_b64_tr_b16 v[192:193], v235 offset:8704
  ds_read_b64_tr_b16 v[194:195], v235 offset:9792
  ds_read_b64_tr_b16 v[196:197], v234 offset:17408
  ds_read_b64_tr_b16 v[198:199], v234 offset:18496
  ds_read_b64_tr_b16 v[200:201], v235 offset:17408
  ds_read_b64_tr_b16 v[202:203], v235 offset:18496
  ds_read_b64_tr_b16 v[204:205], v234 offset:26112
  ds_read_b64_tr_b16 v[206:207], v234 offset:27200
  ds_read_b64_tr_b16 v[208:209], v235 offset:26112
  ds_read_b64_tr_b16 v[210:211], v235 offset:27200
  ds_read_b64_tr_b16 v[212:213], v234 offset:34816
  ds_read_b64_tr_b16 v[214:215], v234 offset:35904
  ds_read_b64_tr_b16 v[216:217], v235 offset:34816
  ds_read_b64_tr_b16 v[218:219], v235 offset:35904
  ds_read_b64_tr_b16 v[220:221], v234 offset:43520
  ds_read_b64_tr_b16 v[222:223], v234 offset:44608
  ds_read_b64_tr_b16 v[224:225], v235 offset:43520
  ds_read_b64_tr_b16 v[226:227], v235 offset:44608
L_proj:
  s_waitcnt lgkmcnt(0)
  s_barrier
  ds_read_b128 v[8:11], v228 offset:40960
  ds_read_b128 v[12:15], v228 offset:41024
  ds_read_b128 v[16:19], v228 offset:41088
  ds_read_b128 v[20:23], v228 offset:41152
  ds_read_b128 v[24:27], v228 offset:41216
  ds_read_b128 v[28:31], v228 offset:41280
  s_waitcnt lgkmcnt(5)
  v_mfma_f32_16x16x32_bf16 v[32:35], v[8:11], v[180:183], 0
  v_mfma_f32_16x16x32_bf16 v[36:39], v[8:11], v[184:187], 0
  s_waitcnt lgkmcnt(4)
  v_mfma_f32_16x16x32_bf16 v[32:35], v[12:15], v[188:191], v[32:35]
  v_mfma_f32_16x16x32_bf16 v[36:39], v[12:15], v[192:195], v[36:39]
  s_waitcnt lgkmcnt(3)
  v_mfma_f32_16x16x32_bf16 v[32:35], v[16:19], v[196:199], v[32:35]
  v_mfma_f32_16x16x32_bf16 v[36:39], v[16:19], v[200:203], v[36:39]
  s_waitcnt lgkmcnt(2)
  v_mfma_f32_16x16x32_bf16 v[32:35], v[20:23], v[204:207], v[32:35]
  v_mfma_f32_16x16x32_bf16 v[36:39], v[20:23], v[208:211], v[36:39]
  s_waitcnt lgkmcnt(1)
  v_mfma_f32_16x16x32_bf16 v[32:35], v[24:27], v[212:215], v[32:35]
  v_mfma_f32_16x16x32_bf16 v[36:39], v[24:27], v[216:219], v[36:39]
  s_waitcnt lgkmcnt(0)
  v_mfma_f32_16x16x32_bf16 v[32:35], v[28:31], v[220:223], v[32:35]
  v_mfma_f32_16x16x32_bf16 v[36:39], v[28:31], v[224:227], v[36:39]
  s_mov_b32 vcc_lo, 0xffff0000
  s_mov_b32 vcc_hi, 0
  s_nop 6
  v_cndmask_b32 v32, v32, v36, vcc
  v_cndmask_b32 v33, v33, v37, vcc
  v_cndmask_b32 v34, v34, v38, vcc
  v_cndmask_b32 v35, v35, v39, vcc
  v_bfi_b32 v32, 15, v236, v32
  v_bfi_b32 v33, 15, v237, v33
  v_bfi_b32 v34, 15, v238, v34
  v_bfi_b32 v35, 15, v239, v35
  s_mov_b32 exec_hi, 0
  s_cmp_eq_u32 s58, 0
  s_cbranch_scc1 L_ythru
  buffer_store_dwordx4 v[32:35], v229, s[44:47], s75 offen
  s_branch L_ydone
L_ythru:
  buffer_store_dwordx4 v[32:35], v229, s[44:47], s75 offen sc1
L_ydone:
  s_mov_b64 exec, -1
  s_cmp_lg_u32 s72, 3
  s_cbranch_scc1 L_end
  s_mov_b32 s52, s32
  s_and_b32 s53, s33, 0xffff
  s_mov_b32 s54, 5120
  s_mov_b32 s55, 0x20000
  s_mov_b32 s12, 0x40000
L_pl157:
  buffer_load_dwordx4 v[8:11], v52, s[44:47], s16 offen sc1
  buffer_load_dwordx4 v[12:15], v52, s[44:47], s17 offen sc1
  s_waitcnt vmcnt(1)
  v_xor_b32 v5, v8, v236
  v_bitop3_b32 v5, v5, v9, v237 bitop3:0xf6
  v_bitop3_b32 v5, v5, v10, v238 bitop3:0xf6
  v_bitop3_b32 v5, v5, v11, v239 bitop3:0xf6
  v_and_b32 v8, -16, v8
  v_and_b32 v9, -16, v9
  v_and_b32 v10, -16, v10
  v_and_b32 v11, -16, v11
  s_waitcnt vmcnt(0)
  v_bitop3_b32 v5, v5, v12, v236 bitop3:0xf6
  v_bitop3_b32 v5, v5, v13, v237 bitop3:0xf6
  v_bitop3_b32 v5, v5, v14, v238 bitop3:0xf6
  v_bitop3_b32 v5, v5, v15, v239 bitop3:0xf6
  v_and_b32 v12, -16, v12
  v_and_b32 v13, -16, v13
  v_and_b32 v14, -16, v14
  v_and_b32 v15, -16, v15
  v_and_b32 v5, 15, v5
  v_cmp_ne_u32 vcc, 0, v5
  v_add_f32 v8, v8, v12
  v_add_f32 v9, v9, v13
  v_add_f32 v10, v10, v14
  v_add_f32 v11, v11, v15
  s_nop 1
  v_permlane16_swap_b32 v8, v9
  v_permlane16_swap_b32 v10, v11
  s_nop 0
  v_add_f32 v8, v8, v9
  v_add_f32 v10, v10, v11
  s_nop 1
  v_permlane32_swap_b32 v8, v10
  s_nop 0
  v_add_f32 v8, v8, v10
  s_nop 1
  v_add_f32_dpp v8, v8, v8 row_ror:4 row_mask:0xf bank_mask:0xf
  s_nop 1
  v_add_f32_dpp v8, v8, v8 row_ror:8 row_mask:0xf bank_mask:0xf
  v_cvt_pk_bf16_f32 v8, v8, v8
  v_lshlrev_b32 v8, 16, v8
  v_add_f32 v8, v46, v8
  v_cvt_pk_bf16_f32 v8, v8, v8
  v_lshlrev_b32 v8, 16, v8
  v_add_f32 v8, v8, v40
  v_cvt_pk_bf16_f32 v8, v8, v8
  s_cmp_eq_u64 vcc, 0
  s_cbranch_scc1 L_pd158
  s_sub_u32 s12, s12, 1
  s_cbranch_scc0 L_pl157
  s_branch L_end
L_pd158:
  s_mov_b32 exec_lo, 0x000f000f
  s_mov_b32 exec_hi, 0x000f000f
  buffer_store_short v8, v53, s[52:55], s62 offen
L_end:
L_exit:
  s_endpgm
.p2align 8
.type L_table,@object
L_table:
  .long 0, 3072, 6144, 66816, 69888, 72960, 133248, 136320
  .long 384, 3456, 6528, 67200, 70272, 73344, 133632, 136704
  .long 768, 3840, 6912, 67584, 70656, 130944, 134016, 137088
  .long 1152, 4224, 7296, 67968, 71040, 131328, 134400, 137472
  .long 32640, 35712, 38784, 99072, 102144, 105216, 165888, 168960
  .long 33024, 36096, 39168, 99456, 102528, 105600, 166272, 169344
  .long 33408, 36480, 39552, 99840, 102912, 105984, 166656, 169728
  .long 33792, 36864, 39936, 100224, 103296, 163968, 167040, 170112
  .long 1536, 4608, 7680, 68352, 71424, 131712, 134784, 137856
  .long 1920, 4992, 65664, 68736, 71808, 132096, 135168, 138240
  .long 2304, 5376, 66048, 69120, 72192, 132480, 135552, 138624
  .long 2688, 5760, 66432, 69504, 72576, 132864, 135936, 139008
  .long 34176, 37248, 40320, 100608, 103680, 164352, 167424, 170496
  .long 34560, 37632, 40704, 100992, 104064, 164736, 167808, 170880
  .long 34944, 38016, 98304, 101376, 104448, 165120, 168192, 171264
  .long 35328, 38400, 98688, 101760, 104832, 165504, 168576, 171648
  .long 81792, 84864, 87936, 148224, 151296, 154368, 18432, 21504
  .long 82176, 85248, 88320, 148608, 151680, 154752, 18816, 21888
  .long 82560, 85632, 88704, 148992, 152064, 155136, 19200, 22272
  .long 82944, 86016, 89088, 149376, 152448, 16512, 19584, 22656
  .long 114816, 117888, 120960, 181248, 184320, 187392, 51072, 54144
  .long 115200, 118272, 121344, 181632, 184704, 187776, 51456, 54528
  .long 115584, 118656, 121728, 182016, 185088, 188160, 51840, 54912
  .long 115968, 119040, 122112, 182400, 185472, 49152, 52224, 55296
  .long 83328, 86400, 89472, 149760, 152832, 16896, 19968, 23040
  .long 83712, 86784, 89856, 150144, 153216, 17280, 20352, 23424
  .long 84096, 87168, 147456, 150528, 153600, 17664, 20736, 23808
  .long 84480, 87552, 147840, 150912, 153984, 18048, 21120, 24192
  .long 116352, 119424, 122496, 182784, 185856, 49536, 52608, 55680
  .long 116736, 119808, 180096, 183168, 186240, 49920, 52992, 56064
  .long 117120, 120192, 180480, 183552, 186624, 50304, 53376, 56448
  .long 117504, 120576, 180864, 183936, 187008, 50688, 53760, 56832
  .long 8064, 11136, 14208, 74496, 77568, 80640, 141312, 144384
  .long 8448, 11520, 14592, 74880, 77952, 81024, 141696, 144768
  .long 8832, 11904, 14976, 75264, 78336, 81408, 142080, 145152
  .long 9216, 12288, 15360, 75648, 78720, 139392, 142464, 145536
  .long 41088, 44160, 47232, 107520, 110592, 113664, 173952, 177024
  .long 41472, 44544, 47616, 107904, 110976, 114048, 174336, 177408
  .long 41856, 44928, 48000, 108288, 111360, 114432, 174720, 177792
  .long 42240, 45312, 48384, 108672, 111744, 172032, 175104, 178176
  .long 9600, 12672, 15744, 76032, 79104, 139776, 142848, 145920
  .long 9984, 13056, 16128, 76416, 79488, 140160, 143232, 146304
  .long 10368, 13440, 73728, 76800, 79872, 140544, 143616, 146688
  .long 10752, 13824, 74112, 77184, 80256, 140928, 144000, 147072
  .long 42624, 45696, 48768, 109056, 112128, 172416, 175488, 178560
  .long 43008, 46080, 106368, 109440, 112512, 172800, 175872, 178944
  .long 43392, 46464, 106752, 109824, 112896, 173184, 176256, 179328
  .long 43776, 46848, 107136, 110208, 113280, 173568, 176640, 179712
  .long 90240, 93312, 96384, 156672, 159744, 162816, 26496, 29568
  .long 90624, 93696, 96768, 157056, 160128, 163200, 26880, 29952
  .long 91008, 94080, 97152, 157440, 160512, 163584, 27264, 30336
  .long 91392, 94464, 97536, 157824, 160896, 24576, 27648, 30720
  .long 122880, 125952, 129024, 189696, 192768, 195840, 59520, 62592
  .long 123264, 126336, 129408, 190080, 193152, 196224, 59904, 62976
  .long 123648, 126720, 129792, 190464, 193536, 57216, 60288, 63360
  .long 124032, 127104, 130176, 190848, 193920, 57600, 60672, 63744
  .long 91776, 94848, 97920, 158208, 161280, 24960, 28032, 31104
  .long 92160, 95232, 155520, 158592, 161664, 25344, 28416, 31488
  .long 92544, 95616, 155904, 158976, 162048, 25728, 28800, 31872
  .long 92928, 96000, 156288, 159360, 162432, 26112, 29184, 32256
  .long 124416, 127488, 130560, 191232, 194304, 57984, 61056, 64128
  .long 124800, 127872, 188544, 191616, 194688, 58368, 61440, 64512
  .long 125184, 128256, 188928, 192000, 195072, 58752, 61824, 64896
  .long 125568, 128640, 189312, 192384, 195456, 59136, 62208, 65280
.size L_table, 2048
.section .rodata,"a"
.p2align 6
.amdhsa_kernel parallel_sum__mha_block_cached__dense_activation_silu__decode_kernel
  .amdhsa_next_free_vgpr 256
  .amdhsa_next_free_sgpr 102
  .amdhsa_accum_offset 256
  .amdhsa_group_segment_fixed_size 0
  .amdhsa_kernarg_size 88
  .amdhsa_user_sgpr_count 2
  .amdhsa_user_sgpr_kernarg_segment_ptr 1
  .amdhsa_system_sgpr_workgroup_id_x 1
.end_amdhsa_kernel
```
